```python
import torch

def _softmax(x, axis=-1):
    return torch.softmax(x, dim=axis)

def _gelu(x):
    return torch.nn.functional.gelu(x, approximate='tanh')

def _silu(x):
    return torch.nn.functional.silu(x)

def _sigmoid(x):
    return torch.sigmoid(x)

def _layernorm(x, axis=-1, eps=1e-05):
    m = x.mean(dim=axis, keepdim=True)
    v = x.var(dim=axis, keepdim=True, unbiased=False)
    return (x - m) / torch.sqrt(v + eps)

def _scatter_add(tgt, idx, src, axis=0):
    return tgt.clone().index_add_(axis, idx, src)

def _segment_sum(src, seg, n):
    out = torch.zeros((n,) + src.shape[1:], dtype=src.dtype)
    return out.index_add_(0, seg, src)

def _pad(x, pw):
    flat = tuple((v for pair in reversed(pw) for v in pair))
    return torch.nn.functional.pad(x, flat)
kernel_name = 'gated_mix__sliding_local_dilated__mixer_gmlp__prompt'

def setup_inputs():

    _w = lambda a: (lambda t: t.to(torch.bfloat16) if t.is_floating_point() else t)(torch.as_tensor(a))

    def _A_setup():
        B, S, D = (1, 2048, 512)
        return {'x': _w((lambda *s: torch.randn(*s, dtype=torch.bfloat16) * 0.05)(B, S, D)), 'wqkv': _w((lambda *s: torch.randn(*s, dtype=torch.bfloat16) * 0.8)(D, 3 * D)), 'wo': _w((lambda *s: torch.randn(*s, dtype=torch.bfloat16) * 0.05)(D, D))}
    _A_in = _A_setup()

    def _B_setup():
        B, S, D, F = (1, 2048, 512, 1376)
        Fh = F // 2
        return {'x': _w((lambda *s: torch.randn(*s, dtype=torch.bfloat16) * 0.05)(B, S, D)), 'w_in': _w((lambda *s: torch.randn(*s, dtype=torch.bfloat16) * 0.4)(D, 2 * Fh)), 'w_sp': _w(0.01 * (lambda *s: torch.randn(*s, dtype=torch.bfloat16) * 0.4)(S, S)), 'b_sp': _w(1.0 + 0.01 * (lambda *s: torch.randn(*s, dtype=torch.bfloat16) * 0.1)(S)), 'w_out': _w((lambda *s: torch.randn(*s, dtype=torch.bfloat16) * 0.1)(Fh, D))}
    _B_in = _B_setup()
    return {'A_x': _A_in['x'], 'A_wqkv': _A_in['wqkv'], 'A_wo': _A_in['wo'], 'B_x': _B_in['x'], 'B_w_in': _B_in['w_in'], 'B_w_sp': _B_in['w_sp'], 'B_b_sp': _B_in['b_sp'], 'B_w_out': _B_in['w_out'], 'gate_w': _w((lambda *s: torch.randn(*s, dtype=torch.bfloat16) * 0.05)(512) * 16.0)}

def reference(A_x, A_wqkv, A_wo, B_x, B_w_in, B_w_sp, B_b_sp, B_w_out, gate_w):

    def _A_ref(x, wqkv, wo):
        B, S, D = x.shape
        H = 32
        Dh = D // H
        W, dil = (8, 2)
        qkv = (lambda x, *d: x.permute(*d))((x @ wqkv).reshape(B, S, 3, H, Dh), 2, 0, 3, 1, 4)
        q, k, v = (qkv[0], qkv[1], qkv[2])
        scale = Dh ** (-0.5)
        pos = torch.arange(S)
        off = torch.arange(W) * dil
        idx = pos[:, None] - off[None, :]
        mask = idx >= 0
        idx_c = torch.where(mask, idx, 0).reshape(-1)
        kg = k[:, :, idx_c, :].reshape(B, H, S, W, Dh)
        vg = v[:, :, idx_c, :].reshape(B, H, S, W, Dh)
        logits = torch.einsum('bhsd,bhswd->bhsw', q, kg) * scale
        logits = torch.where(mask[None, None, :, :], logits, -1000000000.0)
        attn = _softmax(logits, axis=-1)
        o = torch.einsum('bhsw,bhswd->bhsd', attn, vg)
        return (lambda x, *d: x.permute(*d))(o, 0, 2, 1, 3).reshape(B, S, D) @ wo

    def _B_ref(x, w_in, w_sp, b_sp, w_out):
        B, S, D = x.shape
        F = w_in.shape[-1]
        Fh = F // 2
        z = _gelu(torch.einsum('bsd,df->bsf', x, w_in))
        z1 = z[..., :Fh].clone()
        z2 = _layernorm(z[..., Fh:], axis=-1)
        g = torch.einsum('ts,bsf->btf', w_sp, z2) + b_sp[None, :, None]
        return torch.einsum('bsf,fd->bsd', z1 * g, w_out)
    x = A_x
    g = _sigmoid((x * gate_w).sum(-1, keepdims=True))
    a = _A_ref(x, A_wqkv, A_wo)
    b = _B_ref(x, B_w_in, B_w_sp, B_b_sp, B_w_out)
    return g * a + (1 - g) * b
```

```asm
; @launch grid=(256,1,1) block=(512,1,1) lds=163840
.amdgcn_target "amdgcn-amd-amdhsa--gfx950"
.text
.globl gated_mix__sliding_local_dilated__mixer_gmlp__prompt_kernel
.p2align 8
.type gated_mix__sliding_local_dilated__mixer_gmlp__prompt_kernel,@function
gated_mix__sliding_local_dilated__mixer_gmlp__prompt_kernel:
    s_cmp_ge_u32 s2, 256
    s_cbranch_scc1 k1_exit
    s_load_dwordx4 s[28:31], s[0:1], 0
    s_load_dwordx2 s[34:35], s[0:1], 32
    s_load_dwordx2 s[38:39], s[0:1], 40
    s_load_dwordx2 s[32:33], s[0:1], 64
    s_load_dwordx4 s[76:79], s[0:1], 72
    s_load_dwordx2 s[36:37], s[0:1], 88
    v_and_b32 v1, 63, v0
    v_lshrrev_b32 v28, 6, v0
    s_nop 0
    v_readfirstlane_b32 s59, v28
    s_nop 3
    s_mov_b32 s60, s59
    s_lshr_b32 s61, s60, 2
    s_and_b32 s62, s60, 3
    s_mul_i32 s63, s60, 2048
    s_mul_i32 s64, s60, 3072
    s_add_u32 s64, s64, 16384
    s_and_b32 s40, s2, 7
    s_lshr_b32 s41, s2, 3
    s_lshr_b32 s42, s41, 4
    s_and_b32 s43, s41, 15
    s_lshr_b32 s45, s40, 1
    s_lshl_b32 s45, s45, 2
    s_lshr_b32 s46, s43, 2
    s_add_u32 s45, s45, s46
    s_and_b32 s46, s40, 1
    s_lshl_b32 s46, s46, 2
    s_and_b32 s47, s43, 3
    s_add_u32 s46, s46, s47
    s_lshl_b32 s44, s45, 7
    s_and_b32 s47, s46, 3
    s_mul_i32 s47, s47, 192
    s_cmp_ge_u32 s46, 4
    s_cselect_b32 s48, 688, 0
    s_add_u32 s48, s48, s47
    s_lshl_b32 s48, s48, 1
    s_lshl_b32 s49, s46, 7
    s_mov_b32 s52, 2752
    s_mov_b32 s53, 128
    s_cmp_eq_u32 s42, 0
    s_cselect_b32 s52, 3072, s52
    s_cselect_b32 s53, 1024, s53
    s_cselect_b32 s57, s49, s48
    s_lshl_b32 s54, s52, 9
    v_lshrrev_b32 v28, 3, v1
    v_and_b32 v29, 7, v1
    v_xor_b32 v29, v29, v28
    v_lshlrev_b32 v29, 4, v29
    s_mov_b32 s65, 1024
    v_mul_lo_u32 v2, v28, s65
    v_add_u32 v2, v2, v29
    v_add_u32 v28, 0, v1
    s_mov_b32 s65, 2731
    v_mul_lo_u32 v29, v28, s65
    v_lshrrev_b32 v29, 16, v29
    v_mul_u32_u24 v30, 24, v29
    v_sub_u32 v30, v28, v30
    s_lshl_b32 s65, s60, 3
    v_add_u32 v33, s65, v29
    v_bfe_u32 v31, v33, 1, 1
    v_bfe_u32 v32, v33, 3, 1
    v_lshl_or_b32 v31, v32, 1, v31
    v_lshlrev_b32 v31, 1, v31
    v_xor_b32 v30, v30, v31
    v_lshrrev_b32 v31, 3, v30
    v_mul_lo_u32 v31, v31, s53
    v_and_b32 v30, 7, v30
    v_lshl_add_u32 v30, v30, 4, v31
    v_mul_lo_u32 v3, v29, s52
    v_add_u32 v3, v3, v30
    v_add_u32 v28, 64, v1
    s_mov_b32 s65, 2731
    v_mul_lo_u32 v29, v28, s65
    v_lshrrev_b32 v29, 16, v29
    v_mul_u32_u24 v30, 24, v29
    v_sub_u32 v30, v28, v30
    s_lshl_b32 s65, s60, 3
    v_add_u32 v33, s65, v29
    v_bfe_u32 v31, v33, 1, 1
    v_bfe_u32 v32, v33, 3, 1
    v_lshl_or_b32 v31, v32, 1, v31
    v_lshlrev_b32 v31, 1, v31
    v_xor_b32 v30, v30, v31
    v_lshrrev_b32 v31, 3, v30
    v_mul_lo_u32 v31, v31, s53
    v_and_b32 v30, 7, v30
    v_lshl_add_u32 v30, v30, 4, v31
    v_mul_lo_u32 v4, v29, s52
    v_add_u32 v4, v4, v30
    v_add_u32 v28, 128, v1
    s_mov_b32 s65, 2731
    v_mul_lo_u32 v29, v28, s65
    v_lshrrev_b32 v29, 16, v29
    v_mul_u32_u24 v30, 24, v29
    v_sub_u32 v30, v28, v30
    s_lshl_b32 s65, s60, 3
    v_add_u32 v33, s65, v29
    v_bfe_u32 v31, v33, 1, 1
    v_bfe_u32 v32, v33, 3, 1
    v_lshl_or_b32 v31, v32, 1, v31
    v_lshlrev_b32 v31, 1, v31
    v_xor_b32 v30, v30, v31
    v_lshrrev_b32 v31, 3, v30
    v_mul_lo_u32 v31, v31, s53
    v_and_b32 v30, 7, v30
    v_lshl_add_u32 v30, v30, 4, v31
    v_mul_lo_u32 v5, v29, s52
    v_add_u32 v5, v5, v30
    s_lshl_b32 s65, s60, 4
    s_add_u32 s65, s65, s44
    s_lshl_b32 s66, s65, 10
    s_lshl_b32 s65, s60, 3
    s_mul_i32 s65, s65, s52
    s_add_u32 s68, s65, s57
    s_lshl_b32 s58, s52, 6
    s_waitcnt lgkmcnt(0)
    s_cmp_eq_u32 s42, 0
    s_cselect_b32 s50, s30, s34
    s_cselect_b32 s51, s31, s35
    s_mov_b32 s4, s28
    s_mov_b32 s5, s29
    s_mov_b32 s6, 0x200000
    s_mov_b32 s7, 0x00020000
    s_mov_b32 s8, s50
    s_mov_b32 s9, s51
    s_mov_b32 s10, s54
    s_mov_b32 s11, 0x00020000
    s_mov_b32 s24, s78
    s_mov_b32 s25, s79
    s_mov_b32 s26, 0x100
    s_mov_b32 s27, 0x00020000
    s_or_b32 s75, s2, s60
    s_cmp_lg_u32 s75, 0
    s_cbranch_scc1 k1_nn
    s_memrealtime s[74:75]
    s_waitcnt lgkmcnt(0)
    s_or_b32 s74, s74, 1
    v_mov_b32 v28, s74
    v_mov_b32 v29, 0
    v_cmp_eq_u32 vcc, 0, v1
    s_and_saveexec_b64 s[80:81], vcc
    buffer_store_dword v28, v29, s[24:27], 0 offen sc1
    s_mov_b64 exec, s[80:81]
k1_nn:
    s_add_u32 m0, s63, 0
    s_add_u32 s65, s66, 0
    buffer_load_dwordx4 v2, s[4:7], s65 offen lds
    s_add_u32 m0, s63, 1024
    s_add_u32 s65, s66, 8192
    buffer_load_dwordx4 v2, s[4:7], s65 offen lds
    s_add_u32 s66, s66, 128
    s_add_u32 m0, s64, 0
    s_nop 0
    buffer_load_dwordx4 v3, s[8:11], s68 offen lds
    s_add_u32 m0, s64, 1024
    s_nop 0
    buffer_load_dwordx4 v4, s[8:11], s68 offen lds
    s_add_u32 m0, s64, 2048
    s_nop 0
    buffer_load_dwordx4 v5, s[8:11], s68 offen lds
    s_add_u32 s68, s68, s58
    s_add_u32 m0, s63, 40960
    s_add_u32 s65, s66, 0
    buffer_load_dwordx4 v2, s[4:7], s65 offen lds
    s_add_u32 m0, s63, 41984
    s_add_u32 s65, s66, 8192
    buffer_load_dwordx4 v2, s[4:7], s65 offen lds
    s_add_u32 s66, s66, 128
    s_add_u32 m0, s64, 40960
    s_nop 0
    buffer_load_dwordx4 v3, s[8:11], s68 offen lds
    s_add_u32 m0, s64, 41984
    s_nop 0
    buffer_load_dwordx4 v4, s[8:11], s68 offen lds
    s_add_u32 m0, s64, 43008
    s_nop 0
    buffer_load_dwordx4 v5, s[8:11], s68 offen lds
    s_add_u32 s68, s68, s58
    s_add_u32 m0, s63, 81920
    s_add_u32 s65, s66, 0
    buffer_load_dwordx4 v2, s[4:7], s65 offen lds
    s_add_u32 m0, s63, 82944
    s_add_u32 s65, s66, 8192
    buffer_load_dwordx4 v2, s[4:7], s65 offen lds
    s_add_u32 s66, s66, 128
    s_add_u32 m0, s64, 81920
    s_nop 0
    buffer_load_dwordx4 v3, s[8:11], s68 offen lds
    s_add_u32 m0, s64, 82944
    s_nop 0
    buffer_load_dwordx4 v4, s[8:11], s68 offen lds
    s_add_u32 m0, s64, 83968
    s_nop 0
    buffer_load_dwordx4 v5, s[8:11], s68 offen lds
    s_add_u32 s68, s68, s58
    v_and_b32 v28, 15, v1
    s_mul_i32 s65, s61, 64
    v_add_u32 v28, s65, v28
    v_lshlrev_b32 v28, 7, v28
    v_lshrrev_b32 v29, 4, v1
    v_and_b32 v30, 7, v1
    v_add_u32 v31, 0, v29
    v_xor_b32 v31, v31, v30
    v_lshlrev_b32 v31, 4, v31
    v_add_u32 v6, v28, v31
    v_add_u32 v8, 40960, v6
    v_add_u32 v10, 81920, v6
    v_add_u32 v12, 122880, v6
    v_add_u32 v31, 4, v29
    v_xor_b32 v31, v31, v30
    v_lshlrev_b32 v31, 4, v31
    v_add_u32 v7, v28, v31
    v_add_u32 v9, 40960, v7
    v_add_u32 v11, 81920, v7
    v_add_u32 v13, 122880, v7
    v_lshrrev_b32 v29, 4, v1
    v_bfe_u32 v30, v1, 2, 2
    v_lshl_add_u32 v29, v29, 3, v30
    v_bfe_u32 v31, v29, 1, 1
    v_bfe_u32 v32, v29, 3, 1
    v_lshl_or_b32 v31, v32, 1, v31
    v_mul_u32_u24 v29, 384, v29
    v_and_b32 v30, 3, v1
    v_lshl_add_u32 v29, v30, 3, v29
    v_add_u32 v29, 16384, v29
    s_mul_i32 s65, s62, 3
    s_add_u32 s79, s65, 0
    v_xor_b32 v30, s79, v31
    v_lshl_add_u32 v14, v30, 5, v29
    v_add_u32 v17, 40960, v14
    v_add_u32 v20, 81920, v14
    v_add_u32 v23, 122880, v14
    s_add_u32 s79, s65, 1
    v_xor_b32 v30, s79, v31
    v_lshl_add_u32 v15, v30, 5, v29
    v_add_u32 v18, 40960, v15
    v_add_u32 v21, 81920, v15
    v_add_u32 v24, 122880, v15
    s_add_u32 s79, s65, 2
    v_xor_b32 v30, s79, v31
    v_lshl_add_u32 v16, v30, 5, v29
    v_add_u32 v19, 40960, v16
    v_add_u32 v22, 81920, v16
    v_add_u32 v25, 122880, v16
    v_mov_b32 v92, 0
    v_mov_b32 v93, 0
    v_mov_b32 v94, 0
    v_mov_b32 v95, 0
    v_mov_b32 v96, 0
    v_mov_b32 v97, 0
    v_mov_b32 v98, 0
    v_mov_b32 v99, 0
    v_mov_b32 v100, 0
    v_mov_b32 v101, 0
    v_mov_b32 v102, 0
    v_mov_b32 v103, 0
    v_mov_b32 v104, 0
    v_mov_b32 v105, 0
    v_mov_b32 v106, 0
    v_mov_b32 v107, 0
    v_mov_b32 v108, 0
    v_mov_b32 v109, 0
    v_mov_b32 v110, 0
    v_mov_b32 v111, 0
    v_mov_b32 v112, 0
    v_mov_b32 v113, 0
    v_mov_b32 v114, 0
    v_mov_b32 v115, 0
    v_mov_b32 v116, 0
    v_mov_b32 v117, 0
    v_mov_b32 v118, 0
    v_mov_b32 v119, 0
    v_mov_b32 v120, 0
    v_mov_b32 v121, 0
    v_mov_b32 v122, 0
    v_mov_b32 v123, 0
    v_mov_b32 v124, 0
    v_mov_b32 v125, 0
    v_mov_b32 v126, 0
    v_mov_b32 v127, 0
    v_mov_b32 v128, 0
    v_mov_b32 v129, 0
    v_mov_b32 v130, 0
    v_mov_b32 v131, 0
    v_mov_b32 v132, 0
    v_mov_b32 v133, 0
    v_mov_b32 v134, 0
    v_mov_b32 v135, 0
    v_mov_b32 v136, 0
    v_mov_b32 v137, 0
    v_mov_b32 v138, 0
    v_mov_b32 v139, 0
    s_waitcnt vmcnt(10)
    s_barrier
    ds_read_b128 v[36:39], v6 offset:0
    ds_read_b128 v[40:43], v6 offset:2048
    ds_read_b128 v[44:47], v6 offset:4096
    ds_read_b128 v[48:51], v6 offset:6144
    ds_read_b64_tr_b16 v[68:69], v14 offset:0
    ds_read_b64_tr_b16 v[70:71], v14 offset:1536
    ds_read_b64_tr_b16 v[72:73], v15 offset:0
    ds_read_b64_tr_b16 v[74:75], v15 offset:1536
    ds_read_b64_tr_b16 v[76:77], v16 offset:0
    ds_read_b64_tr_b16 v[78:79], v16 offset:1536
    s_waitcnt vmcnt(5)
    s_barrier
    s_waitcnt lgkmcnt(4)
    v_mfma_f32_16x16x32_bf16 v[92:95], v[68:71], v[36:39], v[92:95]
    ds_read_b128 v[52:55], v7 offset:0
    ds_read_b128 v[56:59], v7 offset:2048
    v_mfma_f32_16x16x32_bf16 v[96:99], v[68:71], v[40:43], v[96:99]
    s_add_u32 m0, s63, 122880
    s_add_u32 s65, s66, 0
    buffer_load_dwordx4 v2, s[4:7], s65 offen lds
    v_mfma_f32_16x16x32_bf16 v[100:103], v[68:71], v[44:47], v[100:103]
    ds_read_b128 v[60:63], v7 offset:4096
    v_mfma_f32_16x16x32_bf16 v[104:107], v[68:71], v[48:51], v[104:107]
    ds_read_b128 v[64:67], v7 offset:6144
    s_waitcnt lgkmcnt(6)
    v_mfma_f32_16x16x32_bf16 v[108:111], v[72:75], v[36:39], v[108:111]
    s_add_u32 m0, s63, 123904
    s_add_u32 s65, s66, 8192
    buffer_load_dwordx4 v2, s[4:7], s65 offen lds
    s_add_u32 s66, s66, 128
    v_mfma_f32_16x16x32_bf16 v[112:115], v[72:75], v[40:43], v[112:115]
    ds_read_b64_tr_b16 v[80:81], v14 offset:12288
    v_mfma_f32_16x16x32_bf16 v[116:119], v[72:75], v[44:47], v[116:119]
    ds_read_b64_tr_b16 v[82:83], v14 offset:13824
    v_mfma_f32_16x16x32_bf16 v[120:123], v[72:75], v[48:51], v[120:123]
    s_add_u32 m0, s64, 122880
    s_nop 0
    buffer_load_dwordx4 v3, s[8:11], s68 offen lds
    s_waitcnt lgkmcnt(6)
    v_mfma_f32_16x16x32_bf16 v[124:127], v[76:79], v[36:39], v[124:127]
    ds_read_b64_tr_b16 v[84:85], v15 offset:12288
    v_mfma_f32_16x16x32_bf16 v[128:131], v[76:79], v[40:43], v[128:131]
    ds_read_b64_tr_b16 v[86:87], v15 offset:13824
    v_mfma_f32_16x16x32_bf16 v[132:135], v[76:79], v[44:47], v[132:135]
    ds_read_b64_tr_b16 v[88:89], v16 offset:12288
    v_mfma_f32_16x16x32_bf16 v[136:139], v[76:79], v[48:51], v[136:139]
    ds_read_b64_tr_b16 v[90:91], v16 offset:13824
    s_waitcnt lgkmcnt(4)
    v_mfma_f32_16x16x32_bf16 v[92:95], v[80:83], v[52:55], v[92:95]
    ds_read_b128 v[36:39], v8 offset:0
    v_mfma_f32_16x16x32_bf16 v[96:99], v[80:83], v[56:59], v[96:99]
    ds_read_b128 v[40:43], v8 offset:2048
    v_mfma_f32_16x16x32_bf16 v[100:103], v[80:83], v[60:63], v[100:103]
    s_add_u32 m0, s64, 123904
    s_nop 0
    buffer_load_dwordx4 v4, s[8:11], s68 offen lds
    v_mfma_f32_16x16x32_bf16 v[104:107], v[80:83], v[64:67], v[104:107]
    ds_read_b128 v[44:47], v8 offset:4096
    s_waitcnt lgkmcnt(5)
    v_mfma_f32_16x16x32_bf16 v[108:111], v[84:87], v[52:55], v[108:111]
    ds_read_b128 v[48:51], v8 offset:6144
    v_mfma_f32_16x16x32_bf16 v[112:115], v[84:87], v[56:59], v[112:115]
    s_add_u32 m0, s64, 124928
    s_nop 0
    buffer_load_dwordx4 v5, s[8:11], s68 offen lds
    s_add_u32 s68, s68, s58
    v_mfma_f32_16x16x32_bf16 v[116:119], v[84:87], v[60:63], v[116:119]
    ds_read_b64_tr_b16 v[68:69], v17 offset:0
    v_mfma_f32_16x16x32_bf16 v[120:123], v[84:87], v[64:67], v[120:123]
    ds_read_b64_tr_b16 v[70:71], v17 offset:1536
    s_waitcnt lgkmcnt(6)
    v_mfma_f32_16x16x32_bf16 v[124:127], v[88:91], v[52:55], v[124:127]
    ds_read_b64_tr_b16 v[72:73], v18 offset:0
    v_mfma_f32_16x16x32_bf16 v[128:131], v[88:91], v[56:59], v[128:131]
    ds_read_b64_tr_b16 v[74:75], v18 offset:1536
    v_mfma_f32_16x16x32_bf16 v[132:135], v[88:91], v[60:63], v[132:135]
    ds_read_b64_tr_b16 v[76:77], v19 offset:0
    v_mfma_f32_16x16x32_bf16 v[136:139], v[88:91], v[64:67], v[136:139]
    ds_read_b64_tr_b16 v[78:79], v19 offset:1536
    s_waitcnt vmcnt(5)
    s_barrier
    s_waitcnt lgkmcnt(4)
    v_mfma_f32_16x16x32_bf16 v[92:95], v[68:71], v[36:39], v[92:95]
    ds_read_b128 v[52:55], v9 offset:0
    ds_read_b128 v[56:59], v9 offset:2048
    v_mfma_f32_16x16x32_bf16 v[96:99], v[68:71], v[40:43], v[96:99]
    s_add_u32 m0, s63, 0
    s_add_u32 s65, s66, 0
    buffer_load_dwordx4 v2, s[4:7], s65 offen lds
    v_mfma_f32_16x16x32_bf16 v[100:103], v[68:71], v[44:47], v[100:103]
    ds_read_b128 v[60:63], v9 offset:4096
    v_mfma_f32_16x16x32_bf16 v[104:107], v[68:71], v[48:51], v[104:107]
    ds_read_b128 v[64:67], v9 offset:6144
    s_waitcnt lgkmcnt(6)
    v_mfma_f32_16x16x32_bf16 v[108:111], v[72:75], v[36:39], v[108:111]
    s_add_u32 m0, s63, 1024
    s_add_u32 s65, s66, 8192
    buffer_load_dwordx4 v2, s[4:7], s65 offen lds
    s_add_u32 s66, s66, 128
    v_mfma_f32_16x16x32_bf16 v[112:115], v[72:75], v[40:43], v[112:115]
    ds_read_b64_tr_b16 v[80:81], v17 offset:12288
    v_mfma_f32_16x16x32_bf16 v[116:119], v[72:75], v[44:47], v[116:119]
    ds_read_b64_tr_b16 v[82:83], v17 offset:13824
    v_mfma_f32_16x16x32_bf16 v[120:123], v[72:75], v[48:51], v[120:123]
    s_add_u32 m0, s64, 0
    s_nop 0
    buffer_load_dwordx4 v3, s[8:11], s68 offen lds
    s_waitcnt lgkmcnt(6)
    v_mfma_f32_16x16x32_bf16 v[124:127], v[76:79], v[36:39], v[124:127]
    ds_read_b64_tr_b16 v[84:85], v18 offset:12288
    v_mfma_f32_16x16x32_bf16 v[128:131], v[76:79], v[40:43], v[128:131]
    ds_read_b64_tr_b16 v[86:87], v18 offset:13824
    v_mfma_f32_16x16x32_bf16 v[132:135], v[76:79], v[44:47], v[132:135]
    ds_read_b64_tr_b16 v[88:89], v19 offset:12288
    v_mfma_f32_16x16x32_bf16 v[136:139], v[76:79], v[48:51], v[136:139]
    ds_read_b64_tr_b16 v[90:91], v19 offset:13824
    s_waitcnt lgkmcnt(4)
    v_mfma_f32_16x16x32_bf16 v[92:95], v[80:83], v[52:55], v[92:95]
    ds_read_b128 v[36:39], v10 offset:0
    v_mfma_f32_16x16x32_bf16 v[96:99], v[80:83], v[56:59], v[96:99]
    ds_read_b128 v[40:43], v10 offset:2048
    v_mfma_f32_16x16x32_bf16 v[100:103], v[80:83], v[60:63], v[100:103]
    s_add_u32 m0, s64, 1024
    s_nop 0
    buffer_load_dwordx4 v4, s[8:11], s68 offen lds
    v_mfma_f32_16x16x32_bf16 v[104:107], v[80:83], v[64:67], v[104:107]
    ds_read_b128 v[44:47], v10 offset:4096
    s_waitcnt lgkmcnt(5)
    v_mfma_f32_16x16x32_bf16 v[108:111], v[84:87], v[52:55], v[108:111]
    ds_read_b128 v[48:51], v10 offset:6144
    v_mfma_f32_16x16x32_bf16 v[112:115], v[84:87], v[56:59], v[112:115]
    s_add_u32 m0, s64, 2048
    s_nop 0
    buffer_load_dwordx4 v5, s[8:11], s68 offen lds
    s_add_u32 s68, s68, s58
    v_mfma_f32_16x16x32_bf16 v[116:119], v[84:87], v[60:63], v[116:119]
    ds_read_b64_tr_b16 v[68:69], v20 offset:0
    v_mfma_f32_16x16x32_bf16 v[120:123], v[84:87], v[64:67], v[120:123]
    ds_read_b64_tr_b16 v[70:71], v20 offset:1536
    s_waitcnt lgkmcnt(6)
    v_mfma_f32_16x16x32_bf16 v[124:127], v[88:91], v[52:55], v[124:127]
    ds_read_b64_tr_b16 v[72:73], v21 offset:0
    v_mfma_f32_16x16x32_bf16 v[128:131], v[88:91], v[56:59], v[128:131]
    ds_read_b64_tr_b16 v[74:75], v21 offset:1536
    v_mfma_f32_16x16x32_bf16 v[132:135], v[88:91], v[60:63], v[132:135]
    ds_read_b64_tr_b16 v[76:77], v22 offset:0
    v_mfma_f32_16x16x32_bf16 v[136:139], v[88:91], v[64:67], v[136:139]
    ds_read_b64_tr_b16 v[78:79], v22 offset:1536
    s_waitcnt vmcnt(5)
    s_barrier
    s_waitcnt lgkmcnt(4)
    v_mfma_f32_16x16x32_bf16 v[92:95], v[68:71], v[36:39], v[92:95]
    ds_read_b128 v[52:55], v11 offset:0
    ds_read_b128 v[56:59], v11 offset:2048
    v_mfma_f32_16x16x32_bf16 v[96:99], v[68:71], v[40:43], v[96:99]
    s_add_u32 m0, s63, 40960
    s_add_u32 s65, s66, 0
    buffer_load_dwordx4 v2, s[4:7], s65 offen lds
    v_mfma_f32_16x16x32_bf16 v[100:103], v[68:71], v[44:47], v[100:103]
    ds_read_b128 v[60:63], v11 offset:4096
    v_mfma_f32_16x16x32_bf16 v[104:107], v[68:71], v[48:51], v[104:107]
    ds_read_b128 v[64:67], v11 offset:6144
    s_waitcnt lgkmcnt(6)
    v_mfma_f32_16x16x32_bf16 v[108:111], v[72:75], v[36:39], v[108:111]
    s_add_u32 m0, s63, 41984
    s_add_u32 s65, s66, 8192
    buffer_load_dwordx4 v2, s[4:7], s65 offen lds
    s_add_u32 s66, s66, 128
    v_mfma_f32_16x16x32_bf16 v[112:115], v[72:75], v[40:43], v[112:115]
    ds_read_b64_tr_b16 v[80:81], v20 offset:12288
    v_mfma_f32_16x16x32_bf16 v[116:119], v[72:75], v[44:47], v[116:119]
    ds_read_b64_tr_b16 v[82:83], v20 offset:13824
    v_mfma_f32_16x16x32_bf16 v[120:123], v[72:75], v[48:51], v[120:123]
    s_add_u32 m0, s64, 40960
    s_nop 0
    buffer_load_dwordx4 v3, s[8:11], s68 offen lds
    s_waitcnt lgkmcnt(6)
    v_mfma_f32_16x16x32_bf16 v[124:127], v[76:79], v[36:39], v[124:127]
    ds_read_b64_tr_b16 v[84:85], v21 offset:12288
    v_mfma_f32_16x16x32_bf16 v[128:131], v[76:79], v[40:43], v[128:131]
    ds_read_b64_tr_b16 v[86:87], v21 offset:13824
    v_mfma_f32_16x16x32_bf16 v[132:135], v[76:79], v[44:47], v[132:135]
    ds_read_b64_tr_b16 v[88:89], v22 offset:12288
    v_mfma_f32_16x16x32_bf16 v[136:139], v[76:79], v[48:51], v[136:139]
    ds_read_b64_tr_b16 v[90:91], v22 offset:13824
    s_waitcnt lgkmcnt(4)
    v_mfma_f32_16x16x32_bf16 v[92:95], v[80:83], v[52:55], v[92:95]
    ds_read_b128 v[36:39], v12 offset:0
    v_mfma_f32_16x16x32_bf16 v[96:99], v[80:83], v[56:59], v[96:99]
    ds_read_b128 v[40:43], v12 offset:2048
    v_mfma_f32_16x16x32_bf16 v[100:103], v[80:83], v[60:63], v[100:103]
    s_add_u32 m0, s64, 41984
    s_nop 0
    buffer_load_dwordx4 v4, s[8:11], s68 offen lds
    v_mfma_f32_16x16x32_bf16 v[104:107], v[80:83], v[64:67], v[104:107]
    ds_read_b128 v[44:47], v12 offset:4096
    s_waitcnt lgkmcnt(5)
    v_mfma_f32_16x16x32_bf16 v[108:111], v[84:87], v[52:55], v[108:111]
    ds_read_b128 v[48:51], v12 offset:6144
    v_mfma_f32_16x16x32_bf16 v[112:115], v[84:87], v[56:59], v[112:115]
    s_add_u32 m0, s64, 43008
    s_nop 0
    buffer_load_dwordx4 v5, s[8:11], s68 offen lds
    s_add_u32 s68, s68, s58
    v_mfma_f32_16x16x32_bf16 v[116:119], v[84:87], v[60:63], v[116:119]
    ds_read_b64_tr_b16 v[68:69], v23 offset:0
    v_mfma_f32_16x16x32_bf16 v[120:123], v[84:87], v[64:67], v[120:123]
    ds_read_b64_tr_b16 v[70:71], v23 offset:1536
    s_waitcnt lgkmcnt(6)
    v_mfma_f32_16x16x32_bf16 v[124:127], v[88:91], v[52:55], v[124:127]
    ds_read_b64_tr_b16 v[72:73], v24 offset:0
    v_mfma_f32_16x16x32_bf16 v[128:131], v[88:91], v[56:59], v[128:131]
    ds_read_b64_tr_b16 v[74:75], v24 offset:1536
    v_mfma_f32_16x16x32_bf16 v[132:135], v[88:91], v[60:63], v[132:135]
    ds_read_b64_tr_b16 v[76:77], v25 offset:0
    v_mfma_f32_16x16x32_bf16 v[136:139], v[88:91], v[64:67], v[136:139]
    ds_read_b64_tr_b16 v[78:79], v25 offset:1536
    s_waitcnt vmcnt(5)
    s_barrier
    s_waitcnt lgkmcnt(4)
    v_mfma_f32_16x16x32_bf16 v[92:95], v[68:71], v[36:39], v[92:95]
    ds_read_b128 v[52:55], v13 offset:0
    ds_read_b128 v[56:59], v13 offset:2048
    v_mfma_f32_16x16x32_bf16 v[96:99], v[68:71], v[40:43], v[96:99]
    s_add_u32 m0, s63, 81920
    s_add_u32 s65, s66, 0
    buffer_load_dwordx4 v2, s[4:7], s65 offen lds
    v_mfma_f32_16x16x32_bf16 v[100:103], v[68:71], v[44:47], v[100:103]
    ds_read_b128 v[60:63], v13 offset:4096
    v_mfma_f32_16x16x32_bf16 v[104:107], v[68:71], v[48:51], v[104:107]
    ds_read_b128 v[64:67], v13 offset:6144
    s_waitcnt lgkmcnt(6)
    v_mfma_f32_16x16x32_bf16 v[108:111], v[72:75], v[36:39], v[108:111]
    s_add_u32 m0, s63, 82944
    s_add_u32 s65, s66, 8192
    buffer_load_dwordx4 v2, s[4:7], s65 offen lds
    s_add_u32 s66, s66, 128
    v_mfma_f32_16x16x32_bf16 v[112:115], v[72:75], v[40:43], v[112:115]
    ds_read_b64_tr_b16 v[80:81], v23 offset:12288
    v_mfma_f32_16x16x32_bf16 v[116:119], v[72:75], v[44:47], v[116:119]
    ds_read_b64_tr_b16 v[82:83], v23 offset:13824
    v_mfma_f32_16x16x32_bf16 v[120:123], v[72:75], v[48:51], v[120:123]
    s_add_u32 m0, s64, 81920
    s_nop 0
    buffer_load_dwordx4 v3, s[8:11], s68 offen lds
    s_waitcnt lgkmcnt(6)
    v_mfma_f32_16x16x32_bf16 v[124:127], v[76:79], v[36:39], v[124:127]
    ds_read_b64_tr_b16 v[84:85], v24 offset:12288
    v_mfma_f32_16x16x32_bf16 v[128:131], v[76:79], v[40:43], v[128:131]
    ds_read_b64_tr_b16 v[86:87], v24 offset:13824
    v_mfma_f32_16x16x32_bf16 v[132:135], v[76:79], v[44:47], v[132:135]
    ds_read_b64_tr_b16 v[88:89], v25 offset:12288
    v_mfma_f32_16x16x32_bf16 v[136:139], v[76:79], v[48:51], v[136:139]
    ds_read_b64_tr_b16 v[90:91], v25 offset:13824
    s_waitcnt lgkmcnt(4)
    v_mfma_f32_16x16x32_bf16 v[92:95], v[80:83], v[52:55], v[92:95]
    ds_read_b128 v[36:39], v6 offset:0
    v_mfma_f32_16x16x32_bf16 v[96:99], v[80:83], v[56:59], v[96:99]
    ds_read_b128 v[40:43], v6 offset:2048
    v_mfma_f32_16x16x32_bf16 v[100:103], v[80:83], v[60:63], v[100:103]
    s_add_u32 m0, s64, 82944
    s_nop 0
    buffer_load_dwordx4 v4, s[8:11], s68 offen lds
    v_mfma_f32_16x16x32_bf16 v[104:107], v[80:83], v[64:67], v[104:107]
    ds_read_b128 v[44:47], v6 offset:4096
    s_waitcnt lgkmcnt(5)
    v_mfma_f32_16x16x32_bf16 v[108:111], v[84:87], v[52:55], v[108:111]
    ds_read_b128 v[48:51], v6 offset:6144
    v_mfma_f32_16x16x32_bf16 v[112:115], v[84:87], v[56:59], v[112:115]
    s_add_u32 m0, s64, 83968
    s_nop 0
    buffer_load_dwordx4 v5, s[8:11], s68 offen lds
    s_add_u32 s68, s68, s58
    v_mfma_f32_16x16x32_bf16 v[116:119], v[84:87], v[60:63], v[116:119]
    ds_read_b64_tr_b16 v[68:69], v14 offset:0
    v_mfma_f32_16x16x32_bf16 v[120:123], v[84:87], v[64:67], v[120:123]
    ds_read_b64_tr_b16 v[70:71], v14 offset:1536
    s_waitcnt lgkmcnt(6)
    v_mfma_f32_16x16x32_bf16 v[124:127], v[88:91], v[52:55], v[124:127]
    ds_read_b64_tr_b16 v[72:73], v15 offset:0
    v_mfma_f32_16x16x32_bf16 v[128:131], v[88:91], v[56:59], v[128:131]
    ds_read_b64_tr_b16 v[74:75], v15 offset:1536
    v_mfma_f32_16x16x32_bf16 v[132:135], v[88:91], v[60:63], v[132:135]
    ds_read_b64_tr_b16 v[76:77], v16 offset:0
    v_mfma_f32_16x16x32_bf16 v[136:139], v[88:91], v[64:67], v[136:139]
    ds_read_b64_tr_b16 v[78:79], v16 offset:1536
    s_waitcnt vmcnt(5)
    s_barrier
    s_waitcnt lgkmcnt(4)
    v_mfma_f32_16x16x32_bf16 v[92:95], v[68:71], v[36:39], v[92:95]
    ds_read_b128 v[52:55], v7 offset:0
    ds_read_b128 v[56:59], v7 offset:2048
    v_mfma_f32_16x16x32_bf16 v[96:99], v[68:71], v[40:43], v[96:99]
    s_add_u32 m0, s63, 122880
    s_add_u32 s65, s66, 0
    buffer_load_dwordx4 v2, s[4:7], s65 offen lds
    v_mfma_f32_16x16x32_bf16 v[100:103], v[68:71], v[44:47], v[100:103]
    ds_read_b128 v[60:63], v7 offset:4096
    v_mfma_f32_16x16x32_bf16 v[104:107], v[68:71], v[48:51], v[104:107]
    ds_read_b128 v[64:67], v7 offset:6144
    s_waitcnt lgkmcnt(6)
    v_mfma_f32_16x16x32_bf16 v[108:111], v[72:75], v[36:39], v[108:111]
    s_add_u32 m0, s63, 123904
    s_add_u32 s65, s66, 8192
    buffer_load_dwordx4 v2, s[4:7], s65 offen lds
    s_add_u32 s66, s66, 128
    v_mfma_f32_16x16x32_bf16 v[112:115], v[72:75], v[40:43], v[112:115]
    ds_read_b64_tr_b16 v[80:81], v14 offset:12288
    v_mfma_f32_16x16x32_bf16 v[116:119], v[72:75], v[44:47], v[116:119]
    ds_read_b64_tr_b16 v[82:83], v14 offset:13824
    v_mfma_f32_16x16x32_bf16 v[120:123], v[72:75], v[48:51], v[120:123]
    s_add_u32 m0, s64, 122880
    s_nop 0
    buffer_load_dwordx4 v3, s[8:11], s68 offen lds
    s_waitcnt lgkmcnt(6)
    v_mfma_f32_16x16x32_bf16 v[124:127], v[76:79], v[36:39], v[124:127]
    ds_read_b64_tr_b16 v[84:85], v15 offset:12288
    v_mfma_f32_16x16x32_bf16 v[128:131], v[76:79], v[40:43], v[128:131]
    ds_read_b64_tr_b16 v[86:87], v15 offset:13824
    v_mfma_f32_16x16x32_bf16 v[132:135], v[76:79], v[44:47], v[132:135]
    ds_read_b64_tr_b16 v[88:89], v16 offset:12288
    v_mfma_f32_16x16x32_bf16 v[136:139], v[76:79], v[48:51], v[136:139]
    ds_read_b64_tr_b16 v[90:91], v16 offset:13824
    s_waitcnt lgkmcnt(4)
    v_mfma_f32_16x16x32_bf16 v[92:95], v[80:83], v[52:55], v[92:95]
    ds_read_b128 v[36:39], v8 offset:0
    v_mfma_f32_16x16x32_bf16 v[96:99], v[80:83], v[56:59], v[96:99]
    ds_read_b128 v[40:43], v8 offset:2048
    v_mfma_f32_16x16x32_bf16 v[100:103], v[80:83], v[60:63], v[100:103]
    s_add_u32 m0, s64, 123904
    s_nop 0
    buffer_load_dwordx4 v4, s[8:11], s68 offen lds
    v_mfma_f32_16x16x32_bf16 v[104:107], v[80:83], v[64:67], v[104:107]
    ds_read_b128 v[44:47], v8 offset:4096
    s_waitcnt lgkmcnt(5)
    v_mfma_f32_16x16x32_bf16 v[108:111], v[84:87], v[52:55], v[108:111]
    ds_read_b128 v[48:51], v8 offset:6144
    v_mfma_f32_16x16x32_bf16 v[112:115], v[84:87], v[56:59], v[112:115]
    s_add_u32 m0, s64, 124928
    s_nop 0
    buffer_load_dwordx4 v5, s[8:11], s68 offen lds
    s_add_u32 s68, s68, s58
    v_mfma_f32_16x16x32_bf16 v[116:119], v[84:87], v[60:63], v[116:119]
    ds_read_b64_tr_b16 v[68:69], v17 offset:0
    v_mfma_f32_16x16x32_bf16 v[120:123], v[84:87], v[64:67], v[120:123]
    ds_read_b64_tr_b16 v[70:71], v17 offset:1536
    s_waitcnt lgkmcnt(6)
    v_mfma_f32_16x16x32_bf16 v[124:127], v[88:91], v[52:55], v[124:127]
    ds_read_b64_tr_b16 v[72:73], v18 offset:0
    v_mfma_f32_16x16x32_bf16 v[128:131], v[88:91], v[56:59], v[128:131]
    ds_read_b64_tr_b16 v[74:75], v18 offset:1536
    v_mfma_f32_16x16x32_bf16 v[132:135], v[88:91], v[60:63], v[132:135]
    ds_read_b64_tr_b16 v[76:77], v19 offset:0
    v_mfma_f32_16x16x32_bf16 v[136:139], v[88:91], v[64:67], v[136:139]
    ds_read_b64_tr_b16 v[78:79], v19 offset:1536
    s_waitcnt vmcnt(5)
    s_barrier
    s_waitcnt lgkmcnt(4)
    v_mfma_f32_16x16x32_bf16 v[92:95], v[68:71], v[36:39], v[92:95]
    ds_read_b128 v[52:55], v9 offset:0
    v_mfma_f32_16x16x32_bf16 v[96:99], v[68:71], v[40:43], v[96:99]
    ds_read_b128 v[56:59], v9 offset:2048
    v_mfma_f32_16x16x32_bf16 v[100:103], v[68:71], v[44:47], v[100:103]
    ds_read_b128 v[60:63], v9 offset:4096
    v_mfma_f32_16x16x32_bf16 v[104:107], v[68:71], v[48:51], v[104:107]
    ds_read_b128 v[64:67], v9 offset:6144
    s_waitcnt lgkmcnt(6)
    v_mfma_f32_16x16x32_bf16 v[108:111], v[72:75], v[36:39], v[108:111]
    ds_read_b64_tr_b16 v[80:81], v17 offset:12288
    v_mfma_f32_16x16x32_bf16 v[112:115], v[72:75], v[40:43], v[112:115]
    v_mfma_f32_16x16x32_bf16 v[116:119], v[72:75], v[44:47], v[116:119]
    ds_read_b64_tr_b16 v[82:83], v17 offset:13824
    v_mfma_f32_16x16x32_bf16 v[120:123], v[72:75], v[48:51], v[120:123]
    ds_read_b64_tr_b16 v[84:85], v18 offset:12288
    s_waitcnt lgkmcnt(7)
    v_mfma_f32_16x16x32_bf16 v[124:127], v[76:79], v[36:39], v[124:127]
    ds_read_b64_tr_b16 v[86:87], v18 offset:13824
    v_mfma_f32_16x16x32_bf16 v[128:131], v[76:79], v[40:43], v[128:131]
    ds_read_b64_tr_b16 v[88:89], v19 offset:12288
    v_mfma_f32_16x16x32_bf16 v[132:135], v[76:79], v[44:47], v[132:135]
    ds_read_b64_tr_b16 v[90:91], v19 offset:13824
    v_mfma_f32_16x16x32_bf16 v[136:139], v[76:79], v[48:51], v[136:139]
    s_waitcnt lgkmcnt(4)
    v_mfma_f32_16x16x32_bf16 v[92:95], v[80:83], v[52:55], v[92:95]
    ds_read_b128 v[36:39], v10 offset:0
    v_mfma_f32_16x16x32_bf16 v[96:99], v[80:83], v[56:59], v[96:99]
    ds_read_b128 v[40:43], v10 offset:2048
    v_mfma_f32_16x16x32_bf16 v[100:103], v[80:83], v[60:63], v[100:103]
    ds_read_b128 v[44:47], v10 offset:4096
    v_mfma_f32_16x16x32_bf16 v[104:107], v[80:83], v[64:67], v[104:107]
    ds_read_b128 v[48:51], v10 offset:6144
    s_waitcnt lgkmcnt(6)
    v_mfma_f32_16x16x32_bf16 v[108:111], v[84:87], v[52:55], v[108:111]
    ds_read_b64_tr_b16 v[68:69], v20 offset:0
    v_mfma_f32_16x16x32_bf16 v[112:115], v[84:87], v[56:59], v[112:115]
    v_mfma_f32_16x16x32_bf16 v[116:119], v[84:87], v[60:63], v[116:119]
    ds_read_b64_tr_b16 v[70:71], v20 offset:1536
    v_mfma_f32_16x16x32_bf16 v[120:123], v[84:87], v[64:67], v[120:123]
    ds_read_b64_tr_b16 v[72:73], v21 offset:0
    s_waitcnt lgkmcnt(7)
    v_mfma_f32_16x16x32_bf16 v[124:127], v[88:91], v[52:55], v[124:127]
    ds_read_b64_tr_b16 v[74:75], v21 offset:1536
    v_mfma_f32_16x16x32_bf16 v[128:131], v[88:91], v[56:59], v[128:131]
    ds_read_b64_tr_b16 v[76:77], v22 offset:0
    v_mfma_f32_16x16x32_bf16 v[132:135], v[88:91], v[60:63], v[132:135]
    ds_read_b64_tr_b16 v[78:79], v22 offset:1536
    v_mfma_f32_16x16x32_bf16 v[136:139], v[88:91], v[64:67], v[136:139]
    s_waitcnt vmcnt(0)
    s_barrier
    s_waitcnt lgkmcnt(4)
    v_mfma_f32_16x16x32_bf16 v[92:95], v[68:71], v[36:39], v[92:95]
    ds_read_b128 v[52:55], v11 offset:0
    v_mfma_f32_16x16x32_bf16 v[96:99], v[68:71], v[40:43], v[96:99]
    ds_read_b128 v[56:59], v11 offset:2048
    v_mfma_f32_16x16x32_bf16 v[100:103], v[68:71], v[44:47], v[100:103]
    ds_read_b128 v[60:63], v11 offset:4096
    v_mfma_f32_16x16x32_bf16 v[104:107], v[68:71], v[48:51], v[104:107]
    ds_read_b128 v[64:67], v11 offset:6144
    s_waitcnt lgkmcnt(6)
    v_mfma_f32_16x16x32_bf16 v[108:111], v[72:75], v[36:39], v[108:111]
    ds_read_b64_tr_b16 v[80:81], v20 offset:12288
    v_mfma_f32_16x16x32_bf16 v[112:115], v[72:75], v[40:43], v[112:115]
    v_mfma_f32_16x16x32_bf16 v[116:119], v[72:75], v[44:47], v[116:119]
    ds_read_b64_tr_b16 v[82:83], v20 offset:13824
    v_mfma_f32_16x16x32_bf16 v[120:123], v[72:75], v[48:51], v[120:123]
    ds_read_b64_tr_b16 v[84:85], v21 offset:12288
    s_waitcnt lgkmcnt(7)
    v_mfma_f32_16x16x32_bf16 v[124:127], v[76:79], v[36:39], v[124:127]
    ds_read_b64_tr_b16 v[86:87], v21 offset:13824
    v_mfma_f32_16x16x32_bf16 v[128:131], v[76:79], v[40:43], v[128:131]
    ds_read_b64_tr_b16 v[88:89], v22 offset:12288
    v_mfma_f32_16x16x32_bf16 v[132:135], v[76:79], v[44:47], v[132:135]
    ds_read_b64_tr_b16 v[90:91], v22 offset:13824
    v_mfma_f32_16x16x32_bf16 v[136:139], v[76:79], v[48:51], v[136:139]
    s_waitcnt lgkmcnt(4)
    v_mfma_f32_16x16x32_bf16 v[92:95], v[80:83], v[52:55], v[92:95]
    ds_read_b128 v[36:39], v12 offset:0
    v_mfma_f32_16x16x32_bf16 v[96:99], v[80:83], v[56:59], v[96:99]
    ds_read_b128 v[40:43], v12 offset:2048
    v_mfma_f32_16x16x32_bf16 v[100:103], v[80:83], v[60:63], v[100:103]
    ds_read_b128 v[44:47], v12 offset:4096
    v_mfma_f32_16x16x32_bf16 v[104:107], v[80:83], v[64:67], v[104:107]
    ds_read_b128 v[48:51], v12 offset:6144
    s_waitcnt lgkmcnt(6)
    v_mfma_f32_16x16x32_bf16 v[108:111], v[84:87], v[52:55], v[108:111]
    ds_read_b64_tr_b16 v[68:69], v23 offset:0
    v_mfma_f32_16x16x32_bf16 v[112:115], v[84:87], v[56:59], v[112:115]
    v_mfma_f32_16x16x32_bf16 v[116:119], v[84:87], v[60:63], v[116:119]
    ds_read_b64_tr_b16 v[70:71], v23 offset:1536
    v_mfma_f32_16x16x32_bf16 v[120:123], v[84:87], v[64:67], v[120:123]
    ds_read_b64_tr_b16 v[72:73], v24 offset:0
    s_waitcnt lgkmcnt(7)
    v_mfma_f32_16x16x32_bf16 v[124:127], v[88:91], v[52:55], v[124:127]
    ds_read_b64_tr_b16 v[74:75], v24 offset:1536
    v_mfma_f32_16x16x32_bf16 v[128:131], v[88:91], v[56:59], v[128:131]
    ds_read_b64_tr_b16 v[76:77], v25 offset:0
    v_mfma_f32_16x16x32_bf16 v[132:135], v[88:91], v[60:63], v[132:135]
    ds_read_b64_tr_b16 v[78:79], v25 offset:1536
    v_mfma_f32_16x16x32_bf16 v[136:139], v[88:91], v[64:67], v[136:139]
    s_waitcnt lgkmcnt(4)
    v_mfma_f32_16x16x32_bf16 v[92:95], v[68:71], v[36:39], v[92:95]
    ds_read_b128 v[52:55], v13 offset:0
    v_mfma_f32_16x16x32_bf16 v[96:99], v[68:71], v[40:43], v[96:99]
    ds_read_b128 v[56:59], v13 offset:2048
    v_mfma_f32_16x16x32_bf16 v[100:103], v[68:71], v[44:47], v[100:103]
    ds_read_b128 v[60:63], v13 offset:4096
    v_mfma_f32_16x16x32_bf16 v[104:107], v[68:71], v[48:51], v[104:107]
    ds_read_b128 v[64:67], v13 offset:6144
    s_waitcnt lgkmcnt(6)
    v_mfma_f32_16x16x32_bf16 v[108:111], v[72:75], v[36:39], v[108:111]
    ds_read_b64_tr_b16 v[80:81], v23 offset:12288
    v_mfma_f32_16x16x32_bf16 v[112:115], v[72:75], v[40:43], v[112:115]
    v_mfma_f32_16x16x32_bf16 v[116:119], v[72:75], v[44:47], v[116:119]
    ds_read_b64_tr_b16 v[82:83], v23 offset:13824
    v_mfma_f32_16x16x32_bf16 v[120:123], v[72:75], v[48:51], v[120:123]
    ds_read_b64_tr_b16 v[84:85], v24 offset:12288
    s_waitcnt lgkmcnt(7)
    v_mfma_f32_16x16x32_bf16 v[124:127], v[76:79], v[36:39], v[124:127]
    ds_read_b64_tr_b16 v[86:87], v24 offset:13824
    v_mfma_f32_16x16x32_bf16 v[128:131], v[76:79], v[40:43], v[128:131]
    ds_read_b64_tr_b16 v[88:89], v25 offset:12288
    v_mfma_f32_16x16x32_bf16 v[132:135], v[76:79], v[44:47], v[132:135]
    ds_read_b64_tr_b16 v[90:91], v25 offset:13824
    v_mfma_f32_16x16x32_bf16 v[136:139], v[76:79], v[48:51], v[136:139]
    s_waitcnt lgkmcnt(4)
    v_mfma_f32_16x16x32_bf16 v[92:95], v[80:83], v[52:55], v[92:95]
    v_mfma_f32_16x16x32_bf16 v[96:99], v[80:83], v[56:59], v[96:99]
    v_mfma_f32_16x16x32_bf16 v[100:103], v[80:83], v[60:63], v[100:103]
    v_mfma_f32_16x16x32_bf16 v[104:107], v[80:83], v[64:67], v[104:107]
    s_waitcnt lgkmcnt(2)
    v_mfma_f32_16x16x32_bf16 v[108:111], v[84:87], v[52:55], v[108:111]
    v_mfma_f32_16x16x32_bf16 v[112:115], v[84:87], v[56:59], v[112:115]
    v_mfma_f32_16x16x32_bf16 v[116:119], v[84:87], v[60:63], v[116:119]
    v_mfma_f32_16x16x32_bf16 v[120:123], v[84:87], v[64:67], v[120:123]
    s_waitcnt lgkmcnt(0)
    v_mfma_f32_16x16x32_bf16 v[124:127], v[88:91], v[52:55], v[124:127]
    v_mfma_f32_16x16x32_bf16 v[128:131], v[88:91], v[56:59], v[128:131]
    v_mfma_f32_16x16x32_bf16 v[132:135], v[88:91], v[60:63], v[132:135]
    v_mfma_f32_16x16x32_bf16 v[136:139], v[88:91], v[64:67], v[136:139]
    v_and_b32 v28, 15, v1
    s_mul_i32 s65, s61, 64
    v_add_u32 v28, s65, v28
    v_mul_u32_u24 v36, 400, v28
    v_lshrrev_b32 v28, 4, v1
    v_mul_u32_u24 v28, 8, v28
    v_add_u32 v36, v36, v28
    s_mul_i32 s65, s62, 96
    s_add_u32 s65, s65, 0
    v_add_u32 v36, s65, v36
    v_mov_b32 v237, 0
    buffer_load_dword v236, v237, s[24:27], 0 offen sc1
    s_barrier
    s_cmp_eq_u32 s42, 0
    s_cbranch_scc1 k1_q
    v_mov_b32 v40, 0xc0135761
    v_mov_b32 v41, 0xc0135761
    v_mov_b32 v42, 0xbdd2d3e8
    v_mov_b32 v43, 0xbdd2d3e8
    v_mov_b32 v44, 0x3f800000
    v_mov_b32 v45, 0x3f800000
    s_mul_i32 s70, s62, 48
    s_add_u32 s70, s70, s47
    s_sub_i32 s70, 688, s70
    s_ashr_i32 s70, s70, 4
    s_cmp_ge_u32 s46, 4
    s_cbranch_scc1 k1_z2
    s_add_u32 s12, s36, 8388608
    s_addc_u32 s13, s37, 0
    s_mov_b32 s14, 0x560000
    s_mov_b32 s15, 0x00020000
    s_cmp_le_i32 s70, 0
    s_cbranch_scc1 k1_z1st
    v_pk_mul_f32 v[140:141], v[92:93], v[92:93]
    v_pk_mul_f32 v[142:143], v[94:95], v[94:95]
    v_pk_mul_f32 v[144:145], v[96:97], v[96:97]
    v_pk_mul_f32 v[146:147], v[98:99], v[98:99]
    v_pk_mul_f32 v[148:149], v[100:101], v[100:101]
    v_pk_mul_f32 v[150:151], v[102:103], v[102:103]
    v_pk_mul_f32 v[152:153], v[104:105], v[104:105]
    v_pk_mul_f32 v[154:155], v[106:107], v[106:107]
    v_pk_fma_f32 v[140:141], v[140:141], v[42:43], v[40:41]
    v_pk_fma_f32 v[142:143], v[142:143], v[42:43], v[40:41]
    v_pk_fma_f32 v[144:145], v[144:145], v[42:43], v[40:41]
    v_pk_fma_f32 v[146:147], v[146:147], v[42:43], v[40:41]
    v_pk_fma_f32 v[148:149], v[148:149], v[42:43], v[40:41]
    v_pk_fma_f32 v[150:151], v[150:151], v[42:43], v[40:41]
    v_pk_fma_f32 v[152:153], v[152:153], v[42:43], v[40:41]
    v_pk_fma_f32 v[154:155], v[154:155], v[42:43], v[40:41]
    v_pk_mul_f32 v[140:141], v[140:141], v[92:93]
    v_pk_mul_f32 v[142:143], v[142:143], v[94:95]
    v_pk_mul_f32 v[144:145], v[144:145], v[96:97]
    v_pk_mul_f32 v[146:147], v[146:147], v[98:99]
    v_pk_mul_f32 v[148:149], v[148:149], v[100:101]
    v_pk_mul_f32 v[150:151], v[150:151], v[102:103]
    v_pk_mul_f32 v[152:153], v[152:153], v[104:105]
    v_pk_mul_f32 v[154:155], v[154:155], v[106:107]
    v_exp_f32 v140, v140
    v_exp_f32 v141, v141
    v_exp_f32 v142, v142
    v_exp_f32 v143, v143
    v_exp_f32 v144, v144
    v_exp_f32 v145, v145
    v_exp_f32 v146, v146
    v_exp_f32 v147, v147
    v_exp_f32 v148, v148
    v_exp_f32 v149, v149
    v_exp_f32 v150, v150
    v_exp_f32 v151, v151
    v_exp_f32 v152, v152
    v_exp_f32 v153, v153
    v_exp_f32 v154, v154
    v_exp_f32 v155, v155
    s_nop 0
    v_pk_add_f32 v[140:141], v[140:141], v[44:45]
    v_pk_add_f32 v[142:143], v[142:143], v[44:45]
    v_pk_add_f32 v[144:145], v[144:145], v[44:45]
    v_pk_add_f32 v[146:147], v[146:147], v[44:45]
    v_pk_add_f32 v[148:149], v[148:149], v[44:45]
    v_pk_add_f32 v[150:151], v[150:151], v[44:45]
    v_pk_add_f32 v[152:153], v[152:153], v[44:45]
    v_pk_add_f32 v[154:155], v[154:155], v[44:45]
    v_rcp_f32 v140, v140
    v_rcp_f32 v141, v141
    v_rcp_f32 v142, v142
    v_rcp_f32 v143, v143
    v_rcp_f32 v144, v144
    v_rcp_f32 v145, v145
    v_rcp_f32 v146, v146
    v_rcp_f32 v147, v147
    v_rcp_f32 v148, v148
    v_rcp_f32 v149, v149
    v_rcp_f32 v150, v150
    v_rcp_f32 v151, v151
    v_rcp_f32 v152, v152
    v_rcp_f32 v153, v153
    v_rcp_f32 v154, v154
    v_rcp_f32 v155, v155
    s_nop 0
    v_pk_mul_f32 v[92:93], v[92:93], v[140:141]
    v_pk_mul_f32 v[94:95], v[94:95], v[142:143]
    v_pk_mul_f32 v[96:97], v[96:97], v[144:145]
    v_pk_mul_f32 v[98:99], v[98:99], v[146:147]
    v_pk_mul_f32 v[100:101], v[100:101], v[148:149]
    v_pk_mul_f32 v[102:103], v[102:103], v[150:151]
    v_pk_mul_f32 v[104:105], v[104:105], v[152:153]
    v_pk_mul_f32 v[106:107], v[106:107], v[154:155]
    v_cvt_pk_bf16_f32 v52, v92, v93
    v_cvt_pk_bf16_f32 v53, v94, v95
    ds_write_b64 v36, v[52:53] offset:0
    v_cvt_pk_bf16_f32 v54, v96, v97
    v_cvt_pk_bf16_f32 v55, v98, v99
    ds_write_b64 v36, v[54:55] offset:6400
    v_cvt_pk_bf16_f32 v56, v100, v101
    v_cvt_pk_bf16_f32 v57, v102, v103
    ds_write_b64 v36, v[56:57] offset:12800
    v_cvt_pk_bf16_f32 v58, v104, v105
    v_cvt_pk_bf16_f32 v59, v106, v107
    ds_write_b64 v36, v[58:59] offset:19200
    s_cmp_le_i32 s70, 1
    s_cbranch_scc1 k1_z1st
    v_pk_mul_f32 v[140:141], v[108:109], v[108:109]
    v_pk_mul_f32 v[142:143], v[110:111], v[110:111]
    v_pk_mul_f32 v[144:145], v[112:113], v[112:113]
    v_pk_mul_f32 v[146:147], v[114:115], v[114:115]
    v_pk_mul_f32 v[148:149], v[116:117], v[116:117]
    v_pk_mul_f32 v[150:151], v[118:119], v[118:119]
    v_pk_mul_f32 v[152:153], v[120:121], v[120:121]
    v_pk_mul_f32 v[154:155], v[122:123], v[122:123]
    v_pk_fma_f32 v[140:141], v[140:141], v[42:43], v[40:41]
    v_pk_fma_f32 v[142:143], v[142:143], v[42:43], v[40:41]
    v_pk_fma_f32 v[144:145], v[144:145], v[42:43], v[40:41]
    v_pk_fma_f32 v[146:147], v[146:147], v[42:43], v[40:41]
    v_pk_fma_f32 v[148:149], v[148:149], v[42:43], v[40:41]
    v_pk_fma_f32 v[150:151], v[150:151], v[42:43], v[40:41]
    v_pk_fma_f32 v[152:153], v[152:153], v[42:43], v[40:41]
    v_pk_fma_f32 v[154:155], v[154:155], v[42:43], v[40:41]
    v_pk_mul_f32 v[140:141], v[140:141], v[108:109]
    v_pk_mul_f32 v[142:143], v[142:143], v[110:111]
    v_pk_mul_f32 v[144:145], v[144:145], v[112:113]
    v_pk_mul_f32 v[146:147], v[146:147], v[114:115]
    v_pk_mul_f32 v[148:149], v[148:149], v[116:117]
    v_pk_mul_f32 v[150:151], v[150:151], v[118:119]
    v_pk_mul_f32 v[152:153], v[152:153], v[120:121]
    v_pk_mul_f32 v[154:155], v[154:155], v[122:123]
    v_exp_f32 v140, v140
    v_exp_f32 v141, v141
    v_exp_f32 v142, v142
    v_exp_f32 v143, v143
    v_exp_f32 v144, v144
    v_exp_f32 v145, v145
    v_exp_f32 v146, v146
    v_exp_f32 v147, v147
    v_exp_f32 v148, v148
    v_exp_f32 v149, v149
    v_exp_f32 v150, v150
    v_exp_f32 v151, v151
    v_exp_f32 v152, v152
    v_exp_f32 v153, v153
    v_exp_f32 v154, v154
    v_exp_f32 v155, v155
    s_nop 0
    v_pk_add_f32 v[140:141], v[140:141], v[44:45]
    v_pk_add_f32 v[142:143], v[142:143], v[44:45]
    v_pk_add_f32 v[144:145], v[144:145], v[44:45]
    v_pk_add_f32 v[146:147], v[146:147], v[44:45]
    v_pk_add_f32 v[148:149], v[148:149], v[44:45]
    v_pk_add_f32 v[150:151], v[150:151], v[44:45]
    v_pk_add_f32 v[152:153], v[152:153], v[44:45]
    v_pk_add_f32 v[154:155], v[154:155], v[44:45]
    v_rcp_f32 v140, v140
    v_rcp_f32 v141, v141
    v_rcp_f32 v142, v142
    v_rcp_f32 v143, v143
    v_rcp_f32 v144, v144
    v_rcp_f32 v145, v145
    v_rcp_f32 v146, v146
    v_rcp_f32 v147, v147
    v_rcp_f32 v148, v148
    v_rcp_f32 v149, v149
    v_rcp_f32 v150, v150
    v_rcp_f32 v151, v151
    v_rcp_f32 v152, v152
    v_rcp_f32 v153, v153
    v_rcp_f32 v154, v154
    v_rcp_f32 v155, v155
    s_nop 0
    v_pk_mul_f32 v[108:109], v[108:109], v[140:141]
    v_pk_mul_f32 v[110:111], v[110:111], v[142:143]
    v_pk_mul_f32 v[112:113], v[112:113], v[144:145]
    v_pk_mul_f32 v[114:115], v[114:115], v[146:147]
    v_pk_mul_f32 v[116:117], v[116:117], v[148:149]
    v_pk_mul_f32 v[118:119], v[118:119], v[150:151]
    v_pk_mul_f32 v[120:121], v[120:121], v[152:153]
    v_pk_mul_f32 v[122:123], v[122:123], v[154:155]
    v_cvt_pk_bf16_f32 v52, v108, v109
    v_cvt_pk_bf16_f32 v53, v110, v111
    ds_write_b64 v36, v[52:53] offset:32
    v_cvt_pk_bf16_f32 v54, v112, v113
    v_cvt_pk_bf16_f32 v55, v114, v115
    ds_write_b64 v36, v[54:55] offset:6432
    v_cvt_pk_bf16_f32 v56, v116, v117
    v_cvt_pk_bf16_f32 v57, v118, v119
    ds_write_b64 v36, v[56:57] offset:12832
    v_cvt_pk_bf16_f32 v58, v120, v121
    v_cvt_pk_bf16_f32 v59, v122, v123
    ds_write_b64 v36, v[58:59] offset:19232
    s_cmp_le_i32 s70, 2
    s_cbranch_scc1 k1_z1st
    v_pk_mul_f32 v[140:141], v[124:125], v[124:125]
    v_pk_mul_f32 v[142:143], v[126:127], v[126:127]
    v_pk_mul_f32 v[144:145], v[128:129], v[128:129]
    v_pk_mul_f32 v[146:147], v[130:131], v[130:131]
    v_pk_mul_f32 v[148:149], v[132:133], v[132:133]
    v_pk_mul_f32 v[150:151], v[134:135], v[134:135]
    v_pk_mul_f32 v[152:153], v[136:137], v[136:137]
    v_pk_mul_f32 v[154:155], v[138:139], v[138:139]
    v_pk_fma_f32 v[140:141], v[140:141], v[42:43], v[40:41]
    v_pk_fma_f32 v[142:143], v[142:143], v[42:43], v[40:41]
    v_pk_fma_f32 v[144:145], v[144:145], v[42:43], v[40:41]
    v_pk_fma_f32 v[146:147], v[146:147], v[42:43], v[40:41]
    v_pk_fma_f32 v[148:149], v[148:149], v[42:43], v[40:41]
    v_pk_fma_f32 v[150:151], v[150:151], v[42:43], v[40:41]
    v_pk_fma_f32 v[152:153], v[152:153], v[42:43], v[40:41]
    v_pk_fma_f32 v[154:155], v[154:155], v[42:43], v[40:41]
    v_pk_mul_f32 v[140:141], v[140:141], v[124:125]
    v_pk_mul_f32 v[142:143], v[142:143], v[126:127]
    v_pk_mul_f32 v[144:145], v[144:145], v[128:129]
    v_pk_mul_f32 v[146:147], v[146:147], v[130:131]
    v_pk_mul_f32 v[148:149], v[148:149], v[132:133]
    v_pk_mul_f32 v[150:151], v[150:151], v[134:135]
    v_pk_mul_f32 v[152:153], v[152:153], v[136:137]
    v_pk_mul_f32 v[154:155], v[154:155], v[138:139]
    v_exp_f32 v140, v140
    v_exp_f32 v141, v141
    v_exp_f32 v142, v142
    v_exp_f32 v143, v143
    v_exp_f32 v144, v144
    v_exp_f32 v145, v145
    v_exp_f32 v146, v146
    v_exp_f32 v147, v147
    v_exp_f32 v148, v148
    v_exp_f32 v149, v149
    v_exp_f32 v150, v150
    v_exp_f32 v151, v151
    v_exp_f32 v152, v152
    v_exp_f32 v153, v153
    v_exp_f32 v154, v154
    v_exp_f32 v155, v155
    s_nop 0
    v_pk_add_f32 v[140:141], v[140:141], v[44:45]
    v_pk_add_f32 v[142:143], v[142:143], v[44:45]
    v_pk_add_f32 v[144:145], v[144:145], v[44:45]
    v_pk_add_f32 v[146:147], v[146:147], v[44:45]
    v_pk_add_f32 v[148:149], v[148:149], v[44:45]
    v_pk_add_f32 v[150:151], v[150:151], v[44:45]
    v_pk_add_f32 v[152:153], v[152:153], v[44:45]
    v_pk_add_f32 v[154:155], v[154:155], v[44:45]
    v_rcp_f32 v140, v140
    v_rcp_f32 v141, v141
    v_rcp_f32 v142, v142
    v_rcp_f32 v143, v143
    v_rcp_f32 v144, v144
    v_rcp_f32 v145, v145
    v_rcp_f32 v146, v146
    v_rcp_f32 v147, v147
    v_rcp_f32 v148, v148
    v_rcp_f32 v149, v149
    v_rcp_f32 v150, v150
    v_rcp_f32 v151, v151
    v_rcp_f32 v152, v152
    v_rcp_f32 v153, v153
    v_rcp_f32 v154, v154
    v_rcp_f32 v155, v155
    s_nop 0
    v_pk_mul_f32 v[124:125], v[124:125], v[140:141]
    v_pk_mul_f32 v[126:127], v[126:127], v[142:143]
    v_pk_mul_f32 v[128:129], v[128:129], v[144:145]
    v_pk_mul_f32 v[130:131], v[130:131], v[146:147]
    v_pk_mul_f32 v[132:133], v[132:133], v[148:149]
    v_pk_mul_f32 v[134:135], v[134:135], v[150:151]
    v_pk_mul_f32 v[136:137], v[136:137], v[152:153]
    v_pk_mul_f32 v[138:139], v[138:139], v[154:155]
    v_cvt_pk_bf16_f32 v52, v124, v125
    v_cvt_pk_bf16_f32 v53, v126, v127
    ds_write_b64 v36, v[52:53] offset:64
    v_cvt_pk_bf16_f32 v54, v128, v129
    v_cvt_pk_bf16_f32 v55, v130, v131
    ds_write_b64 v36, v[54:55] offset:6464
    v_cvt_pk_bf16_f32 v56, v132, v133
    v_cvt_pk_bf16_f32 v57, v134, v135
    ds_write_b64 v36, v[56:57] offset:12864
    v_cvt_pk_bf16_f32 v58, v136, v137
    v_cvt_pk_bf16_f32 v59, v138, v139
    ds_write_b64 v36, v[58:59] offset:19264
k1_z1st:
    v_add_u32 v28, 0, v1
    s_mov_b32 s65, 2731
    v_mul_lo_u32 v29, v28, s65
    v_lshrrev_b32 v29, 16, v29
    v_mul_u32_u24 v30, 24, v29
    v_sub_u32 v76, v28, v30
    s_mul_i32 s65, s60, 16
    v_add_u32 v29, s65, v29
    v_mul_u32_u24 v68, 400, v29
    v_mul_u32_u24 v30, 16, v76
    v_add_u32 v68, v68, v30
    v_lshlrev_b32 v30, 4, v76
    s_mov_b32 s65, 2752
    v_mul_lo_u32 v72, v29, s65
    v_add_u32 v72, v72, v30
    v_add_u32 v28, 64, v1
    s_mov_b32 s65, 2731
    v_mul_lo_u32 v29, v28, s65
    v_lshrrev_b32 v29, 16, v29
    v_mul_u32_u24 v30, 24, v29
    v_sub_u32 v77, v28, v30
    s_mul_i32 s65, s60, 16
    v_add_u32 v29, s65, v29
    v_mul_u32_u24 v69, 400, v29
    v_mul_u32_u24 v30, 16, v77
    v_add_u32 v69, v69, v30
    v_lshlrev_b32 v30, 4, v77
    s_mov_b32 s65, 2752
    v_mul_lo_u32 v73, v29, s65
    v_add_u32 v73, v73, v30
    v_add_u32 v28, 128, v1
    s_mov_b32 s65, 2731
    v_mul_lo_u32 v29, v28, s65
    v_lshrrev_b32 v29, 16, v29
    v_mul_u32_u24 v30, 24, v29
    v_sub_u32 v78, v28, v30
    s_mul_i32 s65, s60, 16
    v_add_u32 v29, s65, v29
    v_mul_u32_u24 v70, 400, v29
    v_mul_u32_u24 v30, 16, v78
    v_add_u32 v70, v70, v30
    v_lshlrev_b32 v30, 4, v78
    s_mov_b32 s65, 2752
    v_mul_lo_u32 v74, v29, s65
    v_add_u32 v74, v74, v30
    s_sub_u32 s70, 688, s47
    s_lshr_b32 s70, s70, 3
    v_cmp_gt_u32 vcc, s70, v76
    s_nop 1
    v_mov_b32 v28, 0x7ff00000
    v_cndmask_b32 v72, v28, v72, vcc
    v_cmp_gt_u32 vcc, s70, v77
    s_nop 1
    v_mov_b32 v28, 0x7ff00000
    v_cndmask_b32 v73, v28, v73, vcc
    v_cmp_gt_u32 vcc, s70, v78
    s_nop 1
    v_mov_b32 v28, 0x7ff00000
    v_cndmask_b32 v74, v28, v74, vcc
    s_mul_i32 s71, s44, 2752
    s_lshl_b32 s72, s47, 1
    s_add_u32 s71, s71, s72
    s_waitcnt lgkmcnt(0)
    s_barrier
    ds_read_b128 v[140:143], v68 offset:0
    ds_read_b128 v[144:147], v69 offset:0
    ds_read_b128 v[148:151], v70 offset:0
    ds_read_b128 v[152:155], v68 offset:3200
    ds_read_b128 v[156:159], v69 offset:3200
    ds_read_b128 v[160:163], v70 offset:3200
    s_waitcnt lgkmcnt(5)
    buffer_store_dwordx4 v[140:143], v72, s[12:15], s71 offen sc1
    s_waitcnt lgkmcnt(4)
    buffer_store_dwordx4 v[144:147], v73, s[12:15], s71 offen sc1
    s_waitcnt lgkmcnt(3)
    buffer_store_dwordx4 v[148:151], v74, s[12:15], s71 offen sc1
    s_add_u32 s71, s71, 22016
    s_waitcnt lgkmcnt(2)
    buffer_store_dwordx4 v[152:155], v72, s[12:15], s71 offen sc1
    s_waitcnt lgkmcnt(1)
    buffer_store_dwordx4 v[156:159], v73, s[12:15], s71 offen sc1
    s_waitcnt lgkmcnt(0)
    buffer_store_dwordx4 v[160:163], v74, s[12:15], s71 offen sc1
    s_branch k1_end
k1_z2:
    s_add_u32 s12, s36, 16777216
    s_addc_u32 s13, s37, 0
    s_mov_b32 s14, 0x300000
    s_mov_b32 s15, 0x00020000
    s_add_u32 s16, s36, 30408704
    s_addc_u32 s17, s37, 0
    s_mov_b32 s18, 0x20000
    s_mov_b32 s19, 0x00020000
    v_mov_b32 v188, 0
    v_mov_b32 v189, 0
    v_mov_b32 v190, 0
    v_mov_b32 v191, 0
    v_mov_b32 v192, 0
    v_mov_b32 v193, 0
    v_mov_b32 v194, 0
    v_mov_b32 v195, 0
    v_mov_b32 v196, 0
    v_mov_b32 v197, 0
    v_mov_b32 v198, 0
    v_mov_b32 v199, 0
    v_mov_b32 v200, 0
    v_mov_b32 v201, 0
    v_mov_b32 v202, 0
    v_mov_b32 v203, 0
    s_cmp_le_i32 s70, 0
    s_cbranch_scc1 k1_z2red
    v_pk_mul_f32 v[140:141], v[92:93], v[92:93]
    v_pk_mul_f32 v[142:143], v[94:95], v[94:95]
    v_pk_mul_f32 v[144:145], v[96:97], v[96:97]
    v_pk_mul_f32 v[146:147], v[98:99], v[98:99]
    v_pk_mul_f32 v[148:149], v[100:101], v[100:101]
    v_pk_mul_f32 v[150:151], v[102:103], v[102:103]
    v_pk_mul_f32 v[152:153], v[104:105], v[104:105]
    v_pk_mul_f32 v[154:155], v[106:107], v[106:107]
    v_pk_fma_f32 v[140:141], v[140:141], v[42:43], v[40:41]
    v_pk_fma_f32 v[142:143], v[142:143], v[42:43], v[40:41]
    v_pk_fma_f32 v[144:145], v[144:145], v[42:43], v[40:41]
    v_pk_fma_f32 v[146:147], v[146:147], v[42:43], v[40:41]
    v_pk_fma_f32 v[148:149], v[148:149], v[42:43], v[40:41]
    v_pk_fma_f32 v[150:151], v[150:151], v[42:43], v[40:41]
    v_pk_fma_f32 v[152:153], v[152:153], v[42:43], v[40:41]
    v_pk_fma_f32 v[154:155], v[154:155], v[42:43], v[40:41]
    v_pk_mul_f32 v[140:141], v[140:141], v[92:93]
    v_pk_mul_f32 v[142:143], v[142:143], v[94:95]
    v_pk_mul_f32 v[144:145], v[144:145], v[96:97]
    v_pk_mul_f32 v[146:147], v[146:147], v[98:99]
    v_pk_mul_f32 v[148:149], v[148:149], v[100:101]
    v_pk_mul_f32 v[150:151], v[150:151], v[102:103]
    v_pk_mul_f32 v[152:153], v[152:153], v[104:105]
    v_pk_mul_f32 v[154:155], v[154:155], v[106:107]
    v_exp_f32 v140, v140
    v_exp_f32 v141, v141
    v_exp_f32 v142, v142
    v_exp_f32 v143, v143
    v_exp_f32 v144, v144
    v_exp_f32 v145, v145
    v_exp_f32 v146, v146
    v_exp_f32 v147, v147
    v_exp_f32 v148, v148
    v_exp_f32 v149, v149
    v_exp_f32 v150, v150
    v_exp_f32 v151, v151
    v_exp_f32 v152, v152
    v_exp_f32 v153, v153
    v_exp_f32 v154, v154
    v_exp_f32 v155, v155
    s_nop 0
    v_pk_add_f32 v[140:141], v[140:141], v[44:45]
    v_pk_add_f32 v[142:143], v[142:143], v[44:45]
    v_pk_add_f32 v[144:145], v[144:145], v[44:45]
    v_pk_add_f32 v[146:147], v[146:147], v[44:45]
    v_pk_add_f32 v[148:149], v[148:149], v[44:45]
    v_pk_add_f32 v[150:151], v[150:151], v[44:45]
    v_pk_add_f32 v[152:153], v[152:153], v[44:45]
    v_pk_add_f32 v[154:155], v[154:155], v[44:45]
    v_rcp_f32 v140, v140
    v_rcp_f32 v141, v141
    v_rcp_f32 v142, v142
    v_rcp_f32 v143, v143
    v_rcp_f32 v144, v144
    v_rcp_f32 v145, v145
    v_rcp_f32 v146, v146
    v_rcp_f32 v147, v147
    v_rcp_f32 v148, v148
    v_rcp_f32 v149, v149
    v_rcp_f32 v150, v150
    v_rcp_f32 v151, v151
    v_rcp_f32 v152, v152
    v_rcp_f32 v153, v153
    v_rcp_f32 v154, v154
    v_rcp_f32 v155, v155
    s_nop 0
    v_pk_mul_f32 v[92:93], v[92:93], v[140:141]
    v_pk_mul_f32 v[94:95], v[94:95], v[142:143]
    v_pk_mul_f32 v[96:97], v[96:97], v[144:145]
    v_pk_mul_f32 v[98:99], v[98:99], v[146:147]
    v_pk_mul_f32 v[100:101], v[100:101], v[148:149]
    v_pk_mul_f32 v[102:103], v[102:103], v[150:151]
    v_pk_mul_f32 v[104:105], v[104:105], v[152:153]
    v_pk_mul_f32 v[106:107], v[106:107], v[154:155]
    v_cvt_pk_bf16_f32 v52, v92, v93
    v_cvt_pk_bf16_f32 v53, v94, v95
    ds_write_b64 v36, v[52:53] offset:0
    v_cvt_pk_bf16_f32 v54, v96, v97
    v_cvt_pk_bf16_f32 v55, v98, v99
    ds_write_b64 v36, v[54:55] offset:6400
    v_cvt_pk_bf16_f32 v56, v100, v101
    v_cvt_pk_bf16_f32 v57, v102, v103
    ds_write_b64 v36, v[56:57] offset:12800
    v_cvt_pk_bf16_f32 v58, v104, v105
    v_cvt_pk_bf16_f32 v59, v106, v107
    ds_write_b64 v36, v[58:59] offset:19200
    v_pk_add_f32 v[188:189], v[188:189], v[92:93]
    v_pk_fma_f32 v[190:191], v[92:93], v[92:93], v[190:191]
    v_pk_add_f32 v[192:193], v[192:193], v[96:97]
    v_pk_fma_f32 v[194:195], v[96:97], v[96:97], v[194:195]
    v_pk_add_f32 v[196:197], v[196:197], v[100:101]
    v_pk_fma_f32 v[198:199], v[100:101], v[100:101], v[198:199]
    v_pk_add_f32 v[200:201], v[200:201], v[104:105]
    v_pk_fma_f32 v[202:203], v[104:105], v[104:105], v[202:203]
    v_pk_add_f32 v[188:189], v[188:189], v[94:95]
    v_pk_fma_f32 v[190:191], v[94:95], v[94:95], v[190:191]
    v_pk_add_f32 v[192:193], v[192:193], v[98:99]
    v_pk_fma_f32 v[194:195], v[98:99], v[98:99], v[194:195]
    v_pk_add_f32 v[196:197], v[196:197], v[102:103]
    v_pk_fma_f32 v[198:199], v[102:103], v[102:103], v[198:199]
    v_pk_add_f32 v[200:201], v[200:201], v[106:107]
    v_pk_fma_f32 v[202:203], v[106:107], v[106:107], v[202:203]
    s_cmp_le_i32 s70, 1
    s_cbranch_scc1 k1_z2red
    v_pk_mul_f32 v[140:141], v[108:109], v[108:109]
    v_pk_mul_f32 v[142:143], v[110:111], v[110:111]
    v_pk_mul_f32 v[144:145], v[112:113], v[112:113]
    v_pk_mul_f32 v[146:147], v[114:115], v[114:115]
    v_pk_mul_f32 v[148:149], v[116:117], v[116:117]
    v_pk_mul_f32 v[150:151], v[118:119], v[118:119]
    v_pk_mul_f32 v[152:153], v[120:121], v[120:121]
    v_pk_mul_f32 v[154:155], v[122:123], v[122:123]
    v_pk_fma_f32 v[140:141], v[140:141], v[42:43], v[40:41]
    v_pk_fma_f32 v[142:143], v[142:143], v[42:43], v[40:41]
    v_pk_fma_f32 v[144:145], v[144:145], v[42:43], v[40:41]
    v_pk_fma_f32 v[146:147], v[146:147], v[42:43], v[40:41]
    v_pk_fma_f32 v[148:149], v[148:149], v[42:43], v[40:41]
    v_pk_fma_f32 v[150:151], v[150:151], v[42:43], v[40:41]
    v_pk_fma_f32 v[152:153], v[152:153], v[42:43], v[40:41]
    v_pk_fma_f32 v[154:155], v[154:155], v[42:43], v[40:41]
    v_pk_mul_f32 v[140:141], v[140:141], v[108:109]
    v_pk_mul_f32 v[142:143], v[142:143], v[110:111]
    v_pk_mul_f32 v[144:145], v[144:145], v[112:113]
    v_pk_mul_f32 v[146:147], v[146:147], v[114:115]
    v_pk_mul_f32 v[148:149], v[148:149], v[116:117]
    v_pk_mul_f32 v[150:151], v[150:151], v[118:119]
    v_pk_mul_f32 v[152:153], v[152:153], v[120:121]
    v_pk_mul_f32 v[154:155], v[154:155], v[122:123]
    v_exp_f32 v140, v140
    v_exp_f32 v141, v141
    v_exp_f32 v142, v142
    v_exp_f32 v143, v143
    v_exp_f32 v144, v144
    v_exp_f32 v145, v145
    v_exp_f32 v146, v146
    v_exp_f32 v147, v147
    v_exp_f32 v148, v148
    v_exp_f32 v149, v149
    v_exp_f32 v150, v150
    v_exp_f32 v151, v151
    v_exp_f32 v152, v152
    v_exp_f32 v153, v153
    v_exp_f32 v154, v154
    v_exp_f32 v155, v155
    s_nop 0
    v_pk_add_f32 v[140:141], v[140:141], v[44:45]
    v_pk_add_f32 v[142:143], v[142:143], v[44:45]
    v_pk_add_f32 v[144:145], v[144:145], v[44:45]
    v_pk_add_f32 v[146:147], v[146:147], v[44:45]
    v_pk_add_f32 v[148:149], v[148:149], v[44:45]
    v_pk_add_f32 v[150:151], v[150:151], v[44:45]
    v_pk_add_f32 v[152:153], v[152:153], v[44:45]
    v_pk_add_f32 v[154:155], v[154:155], v[44:45]
    v_rcp_f32 v140, v140
    v_rcp_f32 v141, v141
    v_rcp_f32 v142, v142
    v_rcp_f32 v143, v143
    v_rcp_f32 v144, v144
    v_rcp_f32 v145, v145
    v_rcp_f32 v146, v146
    v_rcp_f32 v147, v147
    v_rcp_f32 v148, v148
    v_rcp_f32 v149, v149
    v_rcp_f32 v150, v150
    v_rcp_f32 v151, v151
    v_rcp_f32 v152, v152
    v_rcp_f32 v153, v153
    v_rcp_f32 v154, v154
    v_rcp_f32 v155, v155
    s_nop 0
    v_pk_mul_f32 v[108:109], v[108:109], v[140:141]
    v_pk_mul_f32 v[110:111], v[110:111], v[142:143]
    v_pk_mul_f32 v[112:113], v[112:113], v[144:145]
    v_pk_mul_f32 v[114:115], v[114:115], v[146:147]
    v_pk_mul_f32 v[116:117], v[116:117], v[148:149]
    v_pk_mul_f32 v[118:119], v[118:119], v[150:151]
    v_pk_mul_f32 v[120:121], v[120:121], v[152:153]
    v_pk_mul_f32 v[122:123], v[122:123], v[154:155]
    v_cvt_pk_bf16_f32 v52, v108, v109
    v_cvt_pk_bf16_f32 v53, v110, v111
    ds_write_b64 v36, v[52:53] offset:32
    v_cvt_pk_bf16_f32 v54, v112, v113
    v_cvt_pk_bf16_f32 v55, v114, v115
    ds_write_b64 v36, v[54:55] offset:6432
    v_cvt_pk_bf16_f32 v56, v116, v117
    v_cvt_pk_bf16_f32 v57, v118, v119
    ds_write_b64 v36, v[56:57] offset:12832
    v_cvt_pk_bf16_f32 v58, v120, v121
    v_cvt_pk_bf16_f32 v59, v122, v123
    ds_write_b64 v36, v[58:59] offset:19232
    v_pk_add_f32 v[188:189], v[188:189], v[108:109]
    v_pk_fma_f32 v[190:191], v[108:109], v[108:109], v[190:191]
    v_pk_add_f32 v[192:193], v[192:193], v[112:113]
    v_pk_fma_f32 v[194:195], v[112:113], v[112:113], v[194:195]
    v_pk_add_f32 v[196:197], v[196:197], v[116:117]
    v_pk_fma_f32 v[198:199], v[116:117], v[116:117], v[198:199]
    v_pk_add_f32 v[200:201], v[200:201], v[120:121]
    v_pk_fma_f32 v[202:203], v[120:121], v[120:121], v[202:203]
    v_pk_add_f32 v[188:189], v[188:189], v[110:111]
    v_pk_fma_f32 v[190:191], v[110:111], v[110:111], v[190:191]
    v_pk_add_f32 v[192:193], v[192:193], v[114:115]
    v_pk_fma_f32 v[194:195], v[114:115], v[114:115], v[194:195]
    v_pk_add_f32 v[196:197], v[196:197], v[118:119]
    v_pk_fma_f32 v[198:199], v[118:119], v[118:119], v[198:199]
    v_pk_add_f32 v[200:201], v[200:201], v[122:123]
    v_pk_fma_f32 v[202:203], v[122:123], v[122:123], v[202:203]
    s_cmp_le_i32 s70, 2
    s_cbranch_scc1 k1_z2red
    v_pk_mul_f32 v[140:141], v[124:125], v[124:125]
    v_pk_mul_f32 v[142:143], v[126:127], v[126:127]
    v_pk_mul_f32 v[144:145], v[128:129], v[128:129]
    v_pk_mul_f32 v[146:147], v[130:131], v[130:131]
    v_pk_mul_f32 v[148:149], v[132:133], v[132:133]
    v_pk_mul_f32 v[150:151], v[134:135], v[134:135]
    v_pk_mul_f32 v[152:153], v[136:137], v[136:137]
    v_pk_mul_f32 v[154:155], v[138:139], v[138:139]
    v_pk_fma_f32 v[140:141], v[140:141], v[42:43], v[40:41]
    v_pk_fma_f32 v[142:143], v[142:143], v[42:43], v[40:41]
    v_pk_fma_f32 v[144:145], v[144:145], v[42:43], v[40:41]
    v_pk_fma_f32 v[146:147], v[146:147], v[42:43], v[40:41]
    v_pk_fma_f32 v[148:149], v[148:149], v[42:43], v[40:41]
    v_pk_fma_f32 v[150:151], v[150:151], v[42:43], v[40:41]
    v_pk_fma_f32 v[152:153], v[152:153], v[42:43], v[40:41]
    v_pk_fma_f32 v[154:155], v[154:155], v[42:43], v[40:41]
    v_pk_mul_f32 v[140:141], v[140:141], v[124:125]
    v_pk_mul_f32 v[142:143], v[142:143], v[126:127]
    v_pk_mul_f32 v[144:145], v[144:145], v[128:129]
    v_pk_mul_f32 v[146:147], v[146:147], v[130:131]
    v_pk_mul_f32 v[148:149], v[148:149], v[132:133]
    v_pk_mul_f32 v[150:151], v[150:151], v[134:135]
    v_pk_mul_f32 v[152:153], v[152:153], v[136:137]
    v_pk_mul_f32 v[154:155], v[154:155], v[138:139]
    v_exp_f32 v140, v140
    v_exp_f32 v141, v141
    v_exp_f32 v142, v142
    v_exp_f32 v143, v143
    v_exp_f32 v144, v144
    v_exp_f32 v145, v145
    v_exp_f32 v146, v146
    v_exp_f32 v147, v147
    v_exp_f32 v148, v148
    v_exp_f32 v149, v149
    v_exp_f32 v150, v150
    v_exp_f32 v151, v151
    v_exp_f32 v152, v152
    v_exp_f32 v153, v153
    v_exp_f32 v154, v154
    v_exp_f32 v155, v155
    s_nop 0
    v_pk_add_f32 v[140:141], v[140:141], v[44:45]
    v_pk_add_f32 v[142:143], v[142:143], v[44:45]
    v_pk_add_f32 v[144:145], v[144:145], v[44:45]
    v_pk_add_f32 v[146:147], v[146:147], v[44:45]
    v_pk_add_f32 v[148:149], v[148:149], v[44:45]
    v_pk_add_f32 v[150:151], v[150:151], v[44:45]
    v_pk_add_f32 v[152:153], v[152:153], v[44:45]
    v_pk_add_f32 v[154:155], v[154:155], v[44:45]
    v_rcp_f32 v140, v140
    v_rcp_f32 v141, v141
    v_rcp_f32 v142, v142
    v_rcp_f32 v143, v143
    v_rcp_f32 v144, v144
    v_rcp_f32 v145, v145
    v_rcp_f32 v146, v146
    v_rcp_f32 v147, v147
    v_rcp_f32 v148, v148
    v_rcp_f32 v149, v149
    v_rcp_f32 v150, v150
    v_rcp_f32 v151, v151
    v_rcp_f32 v152, v152
    v_rcp_f32 v153, v153
    v_rcp_f32 v154, v154
    v_rcp_f32 v155, v155
    s_nop 0
    v_pk_mul_f32 v[124:125], v[124:125], v[140:141]
    v_pk_mul_f32 v[126:127], v[126:127], v[142:143]
    v_pk_mul_f32 v[128:129], v[128:129], v[144:145]
    v_pk_mul_f32 v[130:131], v[130:131], v[146:147]
    v_pk_mul_f32 v[132:133], v[132:133], v[148:149]
    v_pk_mul_f32 v[134:135], v[134:135], v[150:151]
    v_pk_mul_f32 v[136:137], v[136:137], v[152:153]
    v_pk_mul_f32 v[138:139], v[138:139], v[154:155]
    v_cvt_pk_bf16_f32 v52, v124, v125
    v_cvt_pk_bf16_f32 v53, v126, v127
    ds_write_b64 v36, v[52:53] offset:64
    v_cvt_pk_bf16_f32 v54, v128, v129
    v_cvt_pk_bf16_f32 v55, v130, v131
    ds_write_b64 v36, v[54:55] offset:6464
    v_cvt_pk_bf16_f32 v56, v132, v133
    v_cvt_pk_bf16_f32 v57, v134, v135
    ds_write_b64 v36, v[56:57] offset:12864
    v_cvt_pk_bf16_f32 v58, v136, v137
    v_cvt_pk_bf16_f32 v59, v138, v139
    ds_write_b64 v36, v[58:59] offset:19264
    v_pk_add_f32 v[188:189], v[188:189], v[124:125]
    v_pk_fma_f32 v[190:191], v[124:125], v[124:125], v[190:191]
    v_pk_add_f32 v[192:193], v[192:193], v[128:129]
    v_pk_fma_f32 v[194:195], v[128:129], v[128:129], v[194:195]
    v_pk_add_f32 v[196:197], v[196:197], v[132:133]
    v_pk_fma_f32 v[198:199], v[132:133], v[132:133], v[198:199]
    v_pk_add_f32 v[200:201], v[200:201], v[136:137]
    v_pk_fma_f32 v[202:203], v[136:137], v[136:137], v[202:203]
    v_pk_add_f32 v[188:189], v[188:189], v[126:127]
    v_pk_fma_f32 v[190:191], v[126:127], v[126:127], v[190:191]
    v_pk_add_f32 v[192:193], v[192:193], v[130:131]
    v_pk_fma_f32 v[194:195], v[130:131], v[130:131], v[194:195]
    v_pk_add_f32 v[196:197], v[196:197], v[134:135]
    v_pk_fma_f32 v[198:199], v[134:135], v[134:135], v[198:199]
    v_pk_add_f32 v[200:201], v[200:201], v[138:139]
    v_pk_fma_f32 v[202:203], v[138:139], v[138:139], v[202:203]
k1_z2red:
    v_add_f32 v68, v188, v189
    v_add_f32 v72, v190, v191
    v_add_f32 v69, v192, v193
    v_add_f32 v73, v194, v195
    v_add_f32 v70, v196, v197
    v_add_f32 v74, v198, v199
    v_add_f32 v71, v200, v201
    v_add_f32 v75, v202, v203
    v_mov_b32 v156, v68
    v_mov_b32 v157, v69
    v_mov_b32 v158, v70
    v_mov_b32 v159, v71
    v_mov_b32 v160, v72
    v_mov_b32 v161, v73
    v_mov_b32 v162, v74
    v_mov_b32 v163, v75
    s_nop 1
    v_permlane16_swap_b32 v68, v156
    v_permlane16_swap_b32 v69, v157
    v_permlane16_swap_b32 v70, v158
    v_permlane16_swap_b32 v71, v159
    v_permlane16_swap_b32 v72, v160
    v_permlane16_swap_b32 v73, v161
    v_permlane16_swap_b32 v74, v162
    v_permlane16_swap_b32 v75, v163
    s_nop 1
    v_add_f32 v68, v68, v156
    v_add_f32 v69, v69, v157
    v_add_f32 v70, v70, v158
    v_add_f32 v71, v71, v159
    v_add_f32 v72, v72, v160
    v_add_f32 v73, v73, v161
    v_add_f32 v74, v74, v162
    v_add_f32 v75, v75, v163
    v_mov_b32 v156, v68
    v_mov_b32 v157, v69
    v_mov_b32 v158, v70
    v_mov_b32 v159, v71
    v_mov_b32 v160, v72
    v_mov_b32 v161, v73
    v_mov_b32 v162, v74
    v_mov_b32 v163, v75
    s_nop 1
    v_permlane32_swap_b32 v68, v156
    v_permlane32_swap_b32 v69, v157
    v_permlane32_swap_b32 v70, v158
    v_permlane32_swap_b32 v71, v159
    v_permlane32_swap_b32 v72, v160
    v_permlane32_swap_b32 v73, v161
    v_permlane32_swap_b32 v74, v162
    v_permlane32_swap_b32 v75, v163
    s_nop 1
    v_add_f32 v68, v68, v156
    v_add_f32 v69, v69, v157
    v_add_f32 v70, v70, v158
    v_add_f32 v71, v71, v159
    v_add_f32 v72, v72, v160
    v_add_f32 v73, v73, v161
    v_add_f32 v74, v74, v162
    v_add_f32 v75, v75, v163
    v_and_b32 v80, 15, v1
    s_lshl_b32 s65, s61, 6
    v_add_u32 v80, s65, v80
    v_lshlrev_b32 v80, 3, v80
    s_lshl_b32 s65, s62, 10
    s_add_u32 s65, s65, 53248
    v_add_u32 v81, s65, v80
    v_mov_b32 v156, v68
    v_mov_b32 v157, v72
    ds_write_b64 v81, v[156:157] offset:0
    v_mov_b32 v158, v69
    v_mov_b32 v159, v73
    ds_write_b64 v81, v[158:159] offset:128
    v_mov_b32 v160, v70
    v_mov_b32 v161, v74
    ds_write_b64 v81, v[160:161] offset:256
    v_mov_b32 v162, v71
    v_mov_b32 v163, v75
    ds_write_b64 v81, v[162:163] offset:384
    s_waitcnt lgkmcnt(0)
    s_barrier
    v_lshlrev_b32 v82, 3, v0
    v_add_u32 v28, 0, v1
    s_mov_b32 s65, 2731
    v_mul_lo_u32 v29, v28, s65
    v_lshrrev_b32 v29, 16, v29
    v_mul_u32_u24 v30, 24, v29
    v_sub_u32 v76, v28, v30
    s_mul_i32 s65, s60, 16
    v_add_u32 v29, s65, v29
    v_mov_b32 v60, v29
    v_mul_u32_u24 v84, 400, v29
    v_mul_u32_u24 v30, 16, v76
    v_add_u32 v84, v84, v30
    v_lshlrev_b32 v30, 4, v76
    s_mov_b32 s65, 192
    v_mul_lo_u32 v88, v29, s65
    v_add_u32 v88, v88, v30
    v_add_u32 v28, 64, v1
    s_mov_b32 s65, 2731
    v_mul_lo_u32 v29, v28, s65
    v_lshrrev_b32 v29, 16, v29
    v_mul_u32_u24 v30, 24, v29
    v_sub_u32 v77, v28, v30
    s_mul_i32 s65, s60, 16
    v_add_u32 v29, s65, v29
    v_mov_b32 v61, v29
    v_mul_u32_u24 v85, 400, v29
    v_mul_u32_u24 v30, 16, v77
    v_add_u32 v85, v85, v30
    v_lshlrev_b32 v30, 4, v77
    s_mov_b32 s65, 192
    v_mul_lo_u32 v89, v29, s65
    v_add_u32 v89, v89, v30
    v_add_u32 v28, 128, v1
    s_mov_b32 s65, 2731
    v_mul_lo_u32 v29, v28, s65
    v_lshrrev_b32 v29, 16, v29
    v_mul_u32_u24 v30, 24, v29
    v_sub_u32 v78, v28, v30
    s_mul_i32 s65, s60, 16
    v_add_u32 v29, s65, v29
    v_mov_b32 v62, v29
    v_mul_u32_u24 v86, 400, v29
    v_mul_u32_u24 v30, 16, v78
    v_add_u32 v86, v86, v30
    v_lshlrev_b32 v30, 4, v78
    s_mov_b32 s65, 192
    v_mul_lo_u32 v90, v29, s65
    v_add_u32 v90, v90, v30
    s_sub_u32 s76, 688, s47
    s_lshr_b32 s76, s76, 3
    v_lshlrev_b32 v60, 3, v60
    v_cmp_le_u32 vcc, 12, v76
    s_nop 1
    v_mov_b32 v28, 393024
    v_cndmask_b32 v28, 0, v28, vcc
    v_add_u32 v88, v88, v28
    v_cmp_gt_u32 vcc, s76, v76
    s_nop 1
    v_mov_b32 v28, 0x7ff00000
    v_cndmask_b32 v88, v28, v88, vcc
    v_lshlrev_b32 v61, 3, v61
    v_cmp_le_u32 vcc, 12, v77
    s_nop 1
    v_mov_b32 v28, 393024
    v_cndmask_b32 v28, 0, v28, vcc
    v_add_u32 v89, v89, v28
    v_cmp_gt_u32 vcc, s76, v77
    s_nop 1
    v_mov_b32 v28, 0x7ff00000
    v_cndmask_b32 v89, v28, v89, vcc
    v_lshlrev_b32 v62, 3, v62
    v_cmp_le_u32 vcc, 12, v78
    s_nop 1
    v_mov_b32 v28, 393024
    v_cndmask_b32 v28, 0, v28, vcc
    v_add_u32 v90, v90, v28
    v_cmp_gt_u32 vcc, s76, v78
    s_nop 1
    v_mov_b32 v28, 0x7ff00000
    v_cndmask_b32 v90, v28, v90, vcc
    s_and_b32 s71, s46, 3
    s_lshl_b32 s72, s45, 2
    s_add_u32 s71, s71, s72
    s_cmp_ge_u32 s60, 2
    s_cbranch_scc1 k1_z2a
    ds_read_b64 v[156:157], v82 offset:53248
    ds_read_b64 v[158:159], v82 offset:54272
    ds_read_b64 v[160:161], v82 offset:55296
    ds_read_b64 v[162:163], v82 offset:56320
    s_waitcnt lgkmcnt(0)
    v_add_f32 v156, v156, v158
    v_add_f32 v160, v160, v162
    v_add_f32 v156, v156, v160
    v_add_f32 v157, v157, v159
    v_add_f32 v161, v161, v163
    v_add_f32 v157, v157, v161
    s_waitcnt vmcnt(0)
k1_ncz:
    v_readfirstlane_b32 s82, v236
    s_nop 3
    s_cmp_lg_u32 s82, 0
    s_cbranch_scc1 k1_ndz
    s_sleep 2
    buffer_load_dword v236, v237, s[24:27], 0 offen sc1
    s_waitcnt vmcnt(0)
    s_branch k1_ncz
k1_ndz:
    v_lshlrev_b32 v83, 4, v0
    v_mov_b32 v172, v156
    v_xor_b32 v173, v236, v156
    v_mov_b32 v174, v157
    v_xor_b32 v175, v236, v157
    s_lshl_b32 s73, s71, 11
    buffer_store_dwordx4 v[172:175], v83, s[16:19], s73 offen sc1
    s_lshl_b32 s73, s72, 11
    s_add_u32 s75, s73, 4096
k1_z2poll:
    buffer_load_dwordx4 v[172:175], v83, s[16:19], s73 offen offset:0 sc1
    buffer_load_dwordx4 v[176:179], v83, s[16:19], s73 offen offset:2048 sc1
    buffer_load_dwordx4 v[180:183], v83, s[16:19], s75 offen offset:0 sc1
    buffer_load_dwordx4 v[184:187], v83, s[16:19], s75 offen offset:2048 sc1
    s_waitcnt vmcnt(0)
    v_mov_b32 v156, 0
    v_xor_b32 v157, v173, v172
    v_xor_b32 v157, v157, v236
    v_or_b32 v156, v156, v157
    v_xor_b32 v157, v175, v174
    v_xor_b32 v157, v157, v236
    v_or_b32 v156, v156, v157
    v_xor_b32 v157, v177, v176
    v_xor_b32 v157, v157, v236
    v_or_b32 v156, v156, v157
    v_xor_b32 v157, v179, v178
    v_xor_b32 v157, v157, v236
    v_or_b32 v156, v156, v157
    v_xor_b32 v157, v181, v180
    v_xor_b32 v157, v157, v236
    v_or_b32 v156, v156, v157
    v_xor_b32 v157, v183, v182
    v_xor_b32 v157, v157, v236
    v_or_b32 v156, v156, v157
    v_xor_b32 v157, v185, v184
    v_xor_b32 v157, v157, v236
    v_or_b32 v156, v156, v157
    v_xor_b32 v157, v187, v186
    v_xor_b32 v157, v157, v236
    v_or_b32 v156, v156, v157
    v_cmp_ne_u32 vcc, 0, v156
    s_nop 3
    s_cmp_eq_u64 vcc, 0
    s_cbranch_scc1 k1_z2b
    s_sleep 4
    s_branch k1_z2poll
k1_z2b:
    v_add_f32 v156, v172, v176
    v_add_f32 v158, v180, v184
    v_add_f32 v156, v156, v158
    v_add_f32 v157, v174, v178
    v_add_f32 v158, v182, v186
    v_add_f32 v157, v157, v158
    v_mul_f32 v156, 0x3abe82fa, v156
    v_mul_f32 v157, 0x3abe82fa, v157
    v_fma_f32 v157, -v156, v156, v157
    v_max_f32 v157, 0, v157
    v_add_f32 v157, 0x3727c5ac, v157
    v_rsq_f32 v157, v157
    s_nop 0
    ds_write_b64 v82, v[156:157] offset:59392
    s_waitcnt lgkmcnt(0)
k1_z2a:
    s_barrier
    s_and_b32 s71, s46, 3
    s_mul_i32 s71, s71, 786432
    s_mul_i32 s72, s44, 192
    s_add_u32 s71, s71, s72
    ds_read_b128 v[140:143], v84 offset:0
    ds_read_b64 v[204:205], v60 offset:59392
    ds_read_b128 v[144:147], v85 offset:0
    ds_read_b64 v[206:207], v61 offset:59392
    ds_read_b128 v[148:151], v86 offset:0
    ds_read_b64 v[208:209], v62 offset:59392
    ds_read_b128 v[152:155], v84 offset:3200
    ds_read_b64 v[210:211], v60 offset:59456
    ds_read_b128 v[156:159], v85 offset:3200
    ds_read_b64 v[212:213], v61 offset:59456
    ds_read_b128 v[160:163], v86 offset:3200
    ds_read_b64 v[214:215], v62 offset:59456
    s_waitcnt lgkmcnt(10)
    v_lshlrev_b32 v188, 16, v140
    v_and_b32 v189, 0xffff0000, v140
    v_lshlrev_b32 v190, 16, v141
    v_and_b32 v191, 0xffff0000, v141
    v_lshlrev_b32 v192, 16, v142
    v_and_b32 v193, 0xffff0000, v142
    v_lshlrev_b32 v194, 16, v143
    v_and_b32 v195, 0xffff0000, v143
    v_sub_f32 v188, v188, v204
    v_sub_f32 v189, v189, v204
    v_sub_f32 v190, v190, v204
    v_sub_f32 v191, v191, v204
    v_sub_f32 v192, v192, v204
    v_sub_f32 v193, v193, v204
    v_sub_f32 v194, v194, v204
    v_sub_f32 v195, v195, v204
    v_mul_f32 v188, v188, v205
    v_mul_f32 v189, v189, v205
    v_mul_f32 v190, v190, v205
    v_mul_f32 v191, v191, v205
    v_mul_f32 v192, v192, v205
    v_mul_f32 v193, v193, v205
    v_mul_f32 v194, v194, v205
    v_mul_f32 v195, v195, v205
    v_cvt_pk_bf16_f32 v140, v188, v189
    v_cvt_pk_bf16_f32 v141, v190, v191
    v_cvt_pk_bf16_f32 v142, v192, v193
    v_cvt_pk_bf16_f32 v143, v194, v195
    buffer_store_dwordx4 v[140:143], v88, s[12:15], s71 offen sc1
    s_waitcnt lgkmcnt(8)
    v_lshlrev_b32 v188, 16, v144
    v_and_b32 v189, 0xffff0000, v144
    v_lshlrev_b32 v190, 16, v145
    v_and_b32 v191, 0xffff0000, v145
    v_lshlrev_b32 v192, 16, v146
    v_and_b32 v193, 0xffff0000, v146
    v_lshlrev_b32 v194, 16, v147
    v_and_b32 v195, 0xffff0000, v147
    v_sub_f32 v188, v188, v206
    v_sub_f32 v189, v189, v206
    v_sub_f32 v190, v190, v206
    v_sub_f32 v191, v191, v206
    v_sub_f32 v192, v192, v206
    v_sub_f32 v193, v193, v206
    v_sub_f32 v194, v194, v206
    v_sub_f32 v195, v195, v206
    v_mul_f32 v188, v188, v207
    v_mul_f32 v189, v189, v207
    v_mul_f32 v190, v190, v207
    v_mul_f32 v191, v191, v207
    v_mul_f32 v192, v192, v207
    v_mul_f32 v193, v193, v207
    v_mul_f32 v194, v194, v207
    v_mul_f32 v195, v195, v207
    v_cvt_pk_bf16_f32 v144, v188, v189
    v_cvt_pk_bf16_f32 v145, v190, v191
    v_cvt_pk_bf16_f32 v146, v192, v193
    v_cvt_pk_bf16_f32 v147, v194, v195
    buffer_store_dwordx4 v[144:147], v89, s[12:15], s71 offen sc1
    s_waitcnt lgkmcnt(6)
    v_lshlrev_b32 v188, 16, v148
    v_and_b32 v189, 0xffff0000, v148
    v_lshlrev_b32 v190, 16, v149
    v_and_b32 v191, 0xffff0000, v149
    v_lshlrev_b32 v192, 16, v150
    v_and_b32 v193, 0xffff0000, v150
    v_lshlrev_b32 v194, 16, v151
    v_and_b32 v195, 0xffff0000, v151
    v_sub_f32 v188, v188, v208
    v_sub_f32 v189, v189, v208
    v_sub_f32 v190, v190, v208
    v_sub_f32 v191, v191, v208
    v_sub_f32 v192, v192, v208
    v_sub_f32 v193, v193, v208
    v_sub_f32 v194, v194, v208
    v_sub_f32 v195, v195, v208
    v_mul_f32 v188, v188, v209
    v_mul_f32 v189, v189, v209
    v_mul_f32 v190, v190, v209
    v_mul_f32 v191, v191, v209
    v_mul_f32 v192, v192, v209
    v_mul_f32 v193, v193, v209
    v_mul_f32 v194, v194, v209
    v_mul_f32 v195, v195, v209
    v_cvt_pk_bf16_f32 v148, v188, v189
    v_cvt_pk_bf16_f32 v149, v190, v191
    v_cvt_pk_bf16_f32 v150, v192, v193
    v_cvt_pk_bf16_f32 v151, v194, v195
    buffer_store_dwordx4 v[148:151], v90, s[12:15], s71 offen sc1
    s_add_u32 s71, s71, 1536
    s_waitcnt lgkmcnt(4)
    v_lshlrev_b32 v188, 16, v152
    v_and_b32 v189, 0xffff0000, v152
    v_lshlrev_b32 v190, 16, v153
    v_and_b32 v191, 0xffff0000, v153
    v_lshlrev_b32 v192, 16, v154
    v_and_b32 v193, 0xffff0000, v154
    v_lshlrev_b32 v194, 16, v155
    v_and_b32 v195, 0xffff0000, v155
    v_sub_f32 v188, v188, v210
    v_sub_f32 v189, v189, v210
    v_sub_f32 v190, v190, v210
    v_sub_f32 v191, v191, v210
    v_sub_f32 v192, v192, v210
    v_sub_f32 v193, v193, v210
    v_sub_f32 v194, v194, v210
    v_sub_f32 v195, v195, v210
    v_mul_f32 v188, v188, v211
    v_mul_f32 v189, v189, v211
    v_mul_f32 v190, v190, v211
    v_mul_f32 v191, v191, v211
    v_mul_f32 v192, v192, v211
    v_mul_f32 v193, v193, v211
    v_mul_f32 v194, v194, v211
    v_mul_f32 v195, v195, v211
    v_cvt_pk_bf16_f32 v152, v188, v189
    v_cvt_pk_bf16_f32 v153, v190, v191
    v_cvt_pk_bf16_f32 v154, v192, v193
    v_cvt_pk_bf16_f32 v155, v194, v195
    buffer_store_dwordx4 v[152:155], v88, s[12:15], s71 offen sc1
    s_waitcnt lgkmcnt(2)
    v_lshlrev_b32 v188, 16, v156
    v_and_b32 v189, 0xffff0000, v156
    v_lshlrev_b32 v190, 16, v157
    v_and_b32 v191, 0xffff0000, v157
    v_lshlrev_b32 v192, 16, v158
    v_and_b32 v193, 0xffff0000, v158
    v_lshlrev_b32 v194, 16, v159
    v_and_b32 v195, 0xffff0000, v159
    v_sub_f32 v188, v188, v212
    v_sub_f32 v189, v189, v212
    v_sub_f32 v190, v190, v212
    v_sub_f32 v191, v191, v212
    v_sub_f32 v192, v192, v212
    v_sub_f32 v193, v193, v212
    v_sub_f32 v194, v194, v212
    v_sub_f32 v195, v195, v212
    v_mul_f32 v188, v188, v213
    v_mul_f32 v189, v189, v213
    v_mul_f32 v190, v190, v213
    v_mul_f32 v191, v191, v213
    v_mul_f32 v192, v192, v213
    v_mul_f32 v193, v193, v213
    v_mul_f32 v194, v194, v213
    v_mul_f32 v195, v195, v213
    v_cvt_pk_bf16_f32 v156, v188, v189
    v_cvt_pk_bf16_f32 v157, v190, v191
    v_cvt_pk_bf16_f32 v158, v192, v193
    v_cvt_pk_bf16_f32 v159, v194, v195
    buffer_store_dwordx4 v[156:159], v89, s[12:15], s71 offen sc1
    s_waitcnt lgkmcnt(0)
    v_lshlrev_b32 v188, 16, v160
    v_and_b32 v189, 0xffff0000, v160
    v_lshlrev_b32 v190, 16, v161
    v_and_b32 v191, 0xffff0000, v161
    v_lshlrev_b32 v192, 16, v162
    v_and_b32 v193, 0xffff0000, v162
    v_lshlrev_b32 v194, 16, v163
    v_and_b32 v195, 0xffff0000, v163
    v_sub_f32 v188, v188, v214
    v_sub_f32 v189, v189, v214
    v_sub_f32 v190, v190, v214
    v_sub_f32 v191, v191, v214
    v_sub_f32 v192, v192, v214
    v_sub_f32 v193, v193, v214
    v_sub_f32 v194, v194, v214
    v_sub_f32 v195, v195, v214
    v_mul_f32 v188, v188, v215
    v_mul_f32 v189, v189, v215
    v_mul_f32 v190, v190, v215
    v_mul_f32 v191, v191, v215
    v_mul_f32 v192, v192, v215
    v_mul_f32 v193, v193, v215
    v_mul_f32 v194, v194, v215
    v_mul_f32 v195, v195, v215
    v_cvt_pk_bf16_f32 v160, v188, v189
    v_cvt_pk_bf16_f32 v161, v190, v191
    v_cvt_pk_bf16_f32 v162, v192, v193
    v_cvt_pk_bf16_f32 v163, v194, v195
    buffer_store_dwordx4 v[160:163], v90, s[12:15], s71 offen sc1
    s_branch k1_end
k1_q:
    s_add_u32 s12, s36, 20971520
    s_addc_u32 s13, s37, 0
    s_mov_b32 s14, 0x200000
    s_mov_b32 s15, 0x00020000
    s_add_u32 s16, s36, 32505856
    s_addc_u32 s17, s37, 0
    s_mov_b32 s18, 0x100000
    s_mov_b32 s19, 0x00020000
    s_mov_b32 s4, s28
    s_mov_b32 s5, s29
    s_mov_b32 s6, 0x200000
    s_mov_b32 s7, 0x00020000
    s_mov_b32 s8, s32
    s_mov_b32 s9, s33
    s_mov_b32 s10, 0x400
    s_mov_b32 s11, 0x00020000
    s_add_u32 s20, s36, 24117248
    s_addc_u32 s21, s37, 0
    s_mov_b32 s22, 0x2000
    s_mov_b32 s23, 0x00020000
    v_cvt_pk_bf16_f32 v52, v92, v93
    v_cvt_pk_bf16_f32 v53, v94, v95
    ds_write_b64 v36, v[52:53] offset:6400
    v_cvt_pk_bf16_f32 v54, v96, v97
    v_cvt_pk_bf16_f32 v55, v98, v99
    ds_write_b64 v36, v[54:55] offset:12800
    v_cvt_pk_bf16_f32 v56, v100, v101
    v_cvt_pk_bf16_f32 v57, v102, v103
    ds_write_b64 v36, v[56:57] offset:19200
    v_cvt_pk_bf16_f32 v58, v104, v105
    v_cvt_pk_bf16_f32 v59, v106, v107
    ds_write_b64 v36, v[58:59] offset:25600
    v_cvt_pk_bf16_f32 v52, v108, v109
    v_cvt_pk_bf16_f32 v53, v110, v111
    ds_write_b64 v36, v[52:53] offset:6432
    v_cvt_pk_bf16_f32 v54, v112, v113
    v_cvt_pk_bf16_f32 v55, v114, v115
    ds_write_b64 v36, v[54:55] offset:12832
    v_cvt_pk_bf16_f32 v56, v116, v117
    v_cvt_pk_bf16_f32 v57, v118, v119
    ds_write_b64 v36, v[56:57] offset:19232
    v_cvt_pk_bf16_f32 v58, v120, v121
    v_cvt_pk_bf16_f32 v59, v122, v123
    ds_write_b64 v36, v[58:59] offset:25632
    v_cvt_pk_bf16_f32 v52, v124, v125
    v_cvt_pk_bf16_f32 v53, v126, v127
    ds_write_b64 v36, v[52:53] offset:6464
    v_cvt_pk_bf16_f32 v54, v128, v129
    v_cvt_pk_bf16_f32 v55, v130, v131
    ds_write_b64 v36, v[54:55] offset:12864
    v_cvt_pk_bf16_f32 v56, v132, v133
    v_cvt_pk_bf16_f32 v57, v134, v135
    ds_write_b64 v36, v[56:57] offset:19264
    v_cvt_pk_bf16_f32 v58, v136, v137
    v_cvt_pk_bf16_f32 v59, v138, v139
    ds_write_b64 v36, v[58:59] offset:25664
    v_lshlrev_b32 v28, 4, v1
    s_lshl_b32 s55, s46, 4
    s_add_u32 s55, s55, s44
    s_lshl_b32 s56, s60, 1
    s_add_u32 s55, s55, s56
    s_lshl_b32 s56, s55, 10
    buffer_load_dwordx4 v[92:95], v28, s[4:7], s56 offen offset:0
    buffer_load_dwordx4 v[96:99], v28, s[4:7], s56 offen offset:1024
    buffer_load_dwordx4 v[100:103], v28, s[8:11], 0 offen
    v_lshrrev_b32 v28, 5, v0
    v_mul_u32_u24 v84, 400, v28
    v_and_b32 v28, 31, v0
    v_lshl_add_u32 v84, v28, 3, v84
    v_add_u32 v84, 128, v84
    v_lshlrev_b32 v85, 4, v0
    v_and_b32 v28, 7, v0
    v_lshrrev_b32 v82, 3, v0
    v_mul_u32_u24 v81, 400, v82
    v_lshl_add_u32 v81, v28, 4, v81
    v_add_u32 v81, 800, v81
    v_add_u32 v80, 5600, v81
    v_lshlrev_b32 v83, 10, v82
    v_lshl_add_u32 v83, v28, 4, v83
    s_lshl_b32 s73, s44, 10
    s_lshl_b32 s74, s46, 7
    s_add_u32 s73, s73, s74
    s_mov_b32 s52, 0x3eb8aa3b
    s_lshl_b32 s70, s45, 3
    s_add_u32 s70, s70, s46
    s_cmp_lg_u32 s45, 0
    s_cbranch_scc1 k1_q1
    v_mov_b32 v88, 0
    v_mov_b32 v89, 0
    ds_write_b64 v84, v[88:89]
k1_q1:
    s_waitcnt lgkmcnt(0)
    s_barrier
    s_waitcnt vmcnt(0)
k1_ncq:
    v_readfirstlane_b32 s82, v236
    s_nop 3
    s_cmp_lg_u32 s82, 0
    s_cbranch_scc1 k1_ndq
    s_sleep 2
    buffer_load_dword v236, v237, s[24:27], 0 offen sc1
    s_waitcnt vmcnt(0)
    s_branch k1_ncq
k1_ndq:
    s_cmp_eq_u32 s45, 15
    s_cbranch_scc1 k1_q2
    ds_read_b64 v[88:89], v84 offset:51200
    s_lshl_b32 s71, s70, 13
    s_waitcnt lgkmcnt(0)
    v_mov_b32 v90, v89
    v_xor_b32 v89, v236, v88
    v_xor_b32 v91, v236, v90
    buffer_store_dwordx4 v[88:91], v85, s[16:19], s71 offen sc1
k1_q2:
    s_mov_b32 s8, s38
    s_mov_b32 s9, s39
    s_mov_b32 s10, 0x800000
    s_mov_b32 s11, 0x00020000
    s_lshr_b32 s74, s40, 1
    s_lshl_b32 s74, s74, 21
    s_lshl_b32 s75, s43, 17
    s_add_u32 s74, s74, s75
    s_lshl_b32 s75, s60, 14
    s_add_u32 s74, s74, s75
    v_lshlrev_b32 v28, 7, v1
    buffer_load_dword v238, v28, s[8:11], s74 offen
    s_add_u32 s74, s74, 8192
    buffer_load_dword v239, v28, s[8:11], s74 offen
    s_add_u32 s74, s74, 8192
    ds_read_b128 v[140:143], v80 offset:25600
    ds_read_b128 v[144:147], v81 offset:31328
    ds_read_b128 v[148:151], v81 offset:30528
    ds_read_b128 v[152:155], v81 offset:29728
    ds_read_b128 v[156:159], v81 offset:28928
    ds_read_b128 v[160:163], v81 offset:28128
    ds_read_b128 v[164:167], v81 offset:27328
    ds_read_b128 v[168:171], v81 offset:26528
    ds_read_b128 v[172:175], v81 offset:25728
    ds_read_b128 v[176:179], v81 offset:31456
    ds_read_b128 v[180:183], v81 offset:30656
    ds_read_b128 v[184:187], v81 offset:29856
    ds_read_b128 v[188:191], v81 offset:29056
    ds_read_b128 v[192:195], v81 offset:28256
    ds_read_b128 v[196:199], v81 offset:27456
    ds_read_b128 v[200:203], v81 offset:26656
    ds_read_b128 v[204:207], v81 offset:25856
    s_waitcnt lgkmcnt(8)
    v_dot2_f32_bf16 v208, v140, v144, 0
    v_dot2_f32_bf16 v209, v140, v148, 0
    v_dot2_f32_bf16 v210, v140, v152, 0
    v_dot2_f32_bf16 v211, v140, v156, 0
    v_dot2_f32_bf16 v212, v140, v160, 0
    v_dot2_f32_bf16 v213, v140, v164, 0
    v_dot2_f32_bf16 v214, v140, v168, 0
    v_dot2_f32_bf16 v215, v140, v172, 0
    v_dot2_f32_bf16 v208, v141, v145, v208
    v_dot2_f32_bf16 v209, v141, v149, v209
    v_dot2_f32_bf16 v210, v141, v153, v210
    v_dot2_f32_bf16 v211, v141, v157, v211
    v_dot2_f32_bf16 v212, v141, v161, v212
    v_dot2_f32_bf16 v213, v141, v165, v213
    v_dot2_f32_bf16 v214, v141, v169, v214
    v_dot2_f32_bf16 v215, v141, v173, v215
    v_dot2_f32_bf16 v208, v142, v146, v208
    v_dot2_f32_bf16 v209, v142, v150, v209
    v_dot2_f32_bf16 v210, v142, v154, v210
    v_dot2_f32_bf16 v211, v142, v158, v211
    v_dot2_f32_bf16 v212, v142, v162, v212
    v_dot2_f32_bf16 v213, v142, v166, v213
    v_dot2_f32_bf16 v214, v142, v170, v214
    v_dot2_f32_bf16 v215, v142, v174, v215
    v_dot2_f32_bf16 v208, v143, v147, v208
    v_dot2_f32_bf16 v209, v143, v151, v209
    v_dot2_f32_bf16 v210, v143, v155, v210
    v_dot2_f32_bf16 v211, v143, v159, v211
    v_dot2_f32_bf16 v212, v143, v163, v212
    v_dot2_f32_bf16 v213, v143, v167, v213
    v_dot2_f32_bf16 v214, v143, v171, v214
    v_dot2_f32_bf16 v215, v143, v175, v215
    s_nop 3
    v_add_f32_dpp v208, v208, v208 quad_perm:[1,0,3,2] row_mask:0xf bank_mask:0xf
    v_add_f32_dpp v209, v209, v209 quad_perm:[1,0,3,2] row_mask:0xf bank_mask:0xf
    v_add_f32_dpp v210, v210, v210 quad_perm:[1,0,3,2] row_mask:0xf bank_mask:0xf
    v_add_f32_dpp v211, v211, v211 quad_perm:[1,0,3,2] row_mask:0xf bank_mask:0xf
    v_add_f32_dpp v212, v212, v212 quad_perm:[1,0,3,2] row_mask:0xf bank_mask:0xf
    v_add_f32_dpp v213, v213, v213 quad_perm:[1,0,3,2] row_mask:0xf bank_mask:0xf
    v_add_f32_dpp v214, v214, v214 quad_perm:[1,0,3,2] row_mask:0xf bank_mask:0xf
    v_add_f32_dpp v215, v215, v215 quad_perm:[1,0,3,2] row_mask:0xf bank_mask:0xf
    v_max3_f32 v232, v208, v209, v210
    v_max3_f32 v233, v211, v212, v213
    v_max3_f32 v232, v232, v214, v215
    v_max_f32 v232, v232, v233
    v_mul_f32 v232, s52, v232
    v_fma_f32 v208, v208, s52, -v232
    v_fma_f32 v209, v209, s52, -v232
    v_fma_f32 v210, v210, s52, -v232
    v_fma_f32 v211, v211, s52, -v232
    v_fma_f32 v212, v212, s52, -v232
    v_fma_f32 v213, v213, s52, -v232
    v_fma_f32 v214, v214, s52, -v232
    v_fma_f32 v215, v215, s52, -v232
    v_exp_f32 v208, v208
    v_exp_f32 v209, v209
    v_exp_f32 v210, v210
    v_exp_f32 v211, v211
    v_exp_f32 v212, v212
    v_exp_f32 v213, v213
    v_exp_f32 v214, v214
    v_exp_f32 v215, v215
    s_nop 0
    v_add_f32 v232, v208, v209
    v_add_f32 v233, v210, v211
    v_add_f32 v234, v212, v213
    v_add_f32 v235, v214, v215
    v_add_f32 v232, v232, v233
    v_add_f32 v234, v234, v235
    v_add_f32 v232, v232, v234
    v_rcp_f32 v232, v232
    s_waitcnt lgkmcnt(0)
    v_lshlrev_b32 v224, 16, v176
    v_and_b32 v225, 0xffff0000, v176
    v_lshlrev_b32 v226, 16, v177
    v_and_b32 v227, 0xffff0000, v177
    v_lshlrev_b32 v228, 16, v178
    v_and_b32 v229, 0xffff0000, v178
    v_lshlrev_b32 v230, 16, v179
    v_and_b32 v231, 0xffff0000, v179
    v_mul_f32 v216, v208, v224
    v_mul_f32 v217, v208, v225
    v_mul_f32 v218, v208, v226
    v_mul_f32 v219, v208, v227
    v_mul_f32 v220, v208, v228
    v_mul_f32 v221, v208, v229
    v_mul_f32 v222, v208, v230
    v_mul_f32 v223, v208, v231
    v_lshlrev_b32 v224, 16, v180
    v_and_b32 v225, 0xffff0000, v180
    v_lshlrev_b32 v226, 16, v181
    v_and_b32 v227, 0xffff0000, v181
    v_lshlrev_b32 v228, 16, v182
    v_and_b32 v229, 0xffff0000, v182
    v_lshlrev_b32 v230, 16, v183
    v_and_b32 v231, 0xffff0000, v183
    v_fmac_f32 v216, v209, v224
    v_fmac_f32 v217, v209, v225
    v_fmac_f32 v218, v209, v226
    v_fmac_f32 v219, v209, v227
    v_fmac_f32 v220, v209, v228
    v_fmac_f32 v221, v209, v229
    v_fmac_f32 v222, v209, v230
    v_fmac_f32 v223, v209, v231
    v_lshlrev_b32 v224, 16, v184
    v_and_b32 v225, 0xffff0000, v184
    v_lshlrev_b32 v226, 16, v185
    v_and_b32 v227, 0xffff0000, v185
    v_lshlrev_b32 v228, 16, v186
    v_and_b32 v229, 0xffff0000, v186
    v_lshlrev_b32 v230, 16, v187
    v_and_b32 v231, 0xffff0000, v187
    v_fmac_f32 v216, v210, v224
    v_fmac_f32 v217, v210, v225
    v_fmac_f32 v218, v210, v226
    v_fmac_f32 v219, v210, v227
    v_fmac_f32 v220, v210, v228
    v_fmac_f32 v221, v210, v229
    v_fmac_f32 v222, v210, v230
    v_fmac_f32 v223, v210, v231
    v_lshlrev_b32 v224, 16, v188
    v_and_b32 v225, 0xffff0000, v188
    v_lshlrev_b32 v226, 16, v189
    v_and_b32 v227, 0xffff0000, v189
    v_lshlrev_b32 v228, 16, v190
    v_and_b32 v229, 0xffff0000, v190
    v_lshlrev_b32 v230, 16, v191
    v_and_b32 v231, 0xffff0000, v191
    v_fmac_f32 v216, v211, v224
    v_fmac_f32 v217, v211, v225
    v_fmac_f32 v218, v211, v226
    v_fmac_f32 v219, v211, v227
    v_fmac_f32 v220, v211, v228
    v_fmac_f32 v221, v211, v229
    v_fmac_f32 v222, v211, v230
    v_fmac_f32 v223, v211, v231
    v_lshlrev_b32 v224, 16, v192
    v_and_b32 v225, 0xffff0000, v192
    v_lshlrev_b32 v226, 16, v193
    v_and_b32 v227, 0xffff0000, v193
    v_lshlrev_b32 v228, 16, v194
    v_and_b32 v229, 0xffff0000, v194
    v_lshlrev_b32 v230, 16, v195
    v_and_b32 v231, 0xffff0000, v195
    v_fmac_f32 v216, v212, v224
    v_fmac_f32 v217, v212, v225
    v_fmac_f32 v218, v212, v226
    v_fmac_f32 v219, v212, v227
    v_fmac_f32 v220, v212, v228
    v_fmac_f32 v221, v212, v229
    v_fmac_f32 v222, v212, v230
    v_fmac_f32 v223, v212, v231
    v_lshlrev_b32 v224, 16, v196
    v_and_b32 v225, 0xffff0000, v196
    v_lshlrev_b32 v226, 16, v197
    v_and_b32 v227, 0xffff0000, v197
    v_lshlrev_b32 v228, 16, v198
    v_and_b32 v229, 0xffff0000, v198
    v_lshlrev_b32 v230, 16, v199
    v_and_b32 v231, 0xffff0000, v199
    v_fmac_f32 v216, v213, v224
    v_fmac_f32 v217, v213, v225
    v_fmac_f32 v218, v213, v226
    v_fmac_f32 v219, v213, v227
    v_fmac_f32 v220, v213, v228
    v_fmac_f32 v221, v213, v229
    v_fmac_f32 v222, v213, v230
    v_fmac_f32 v223, v213, v231
    v_lshlrev_b32 v224, 16, v200
    v_and_b32 v225, 0xffff0000, v200
    v_lshlrev_b32 v226, 16, v201
    v_and_b32 v227, 0xffff0000, v201
    v_lshlrev_b32 v228, 16, v202
    v_and_b32 v229, 0xffff0000, v202
    v_lshlrev_b32 v230, 16, v203
    v_and_b32 v231, 0xffff0000, v203
    v_fmac_f32 v216, v214, v224
    v_fmac_f32 v217, v214, v225
    v_fmac_f32 v218, v214, v226
    v_fmac_f32 v219, v214, v227
    v_fmac_f32 v220, v214, v228
    v_fmac_f32 v221, v214, v229
    v_fmac_f32 v222, v214, v230
    v_fmac_f32 v223, v214, v231
    v_lshlrev_b32 v224, 16, v204
    v_and_b32 v225, 0xffff0000, v204
    v_lshlrev_b32 v226, 16, v205
    v_and_b32 v227, 0xffff0000, v205
    v_lshlrev_b32 v228, 16, v206
    v_and_b32 v229, 0xffff0000, v206
    v_lshlrev_b32 v230, 16, v207
    v_and_b32 v231, 0xffff0000, v207
    v_fmac_f32 v216, v215, v224
    v_fmac_f32 v217, v215, v225
    v_fmac_f32 v218, v215, v226
    v_fmac_f32 v219, v215, v227
    v_fmac_f32 v220, v215, v228
    v_fmac_f32 v221, v215, v229
    v_fmac_f32 v222, v215, v230
    v_fmac_f32 v223, v215, v231
    v_mul_f32 v216, v216, v232
    v_mul_f32 v217, v217, v232
    v_mul_f32 v218, v218, v232
    v_mul_f32 v219, v219, v232
    v_mul_f32 v220, v220, v232
    v_mul_f32 v221, v221, v232
    v_mul_f32 v222, v222, v232
    v_mul_f32 v223, v223, v232
    v_cvt_pk_bf16_f32 v140, v216, v217
    v_cvt_pk_bf16_f32 v141, v218, v219
    v_cvt_pk_bf16_f32 v142, v220, v221
    v_cvt_pk_bf16_f32 v143, v222, v223
    s_add_u32 s65, s73, 65536
    buffer_store_dwordx4 v[140:143], v83, s[12:15], s65 offen sc1
    s_waitcnt vmcnt(1)
    v_dot2_f32_bf16 v104, v92, v100, 0
    v_dot2_f32_bf16 v104, v93, v101, v104
    v_dot2_f32_bf16 v104, v94, v102, v104
    v_dot2_f32_bf16 v104, v95, v103, v104
    v_dot2_f32_bf16 v105, v96, v100, 0
    v_dot2_f32_bf16 v105, v97, v101, v105
    v_dot2_f32_bf16 v105, v98, v102, v105
    v_dot2_f32_bf16 v105, v99, v103, v105
    s_nop 3
    s_nop 1
    v_add_f32_dpp v104, v104, v104 quad_perm:[1,0,3,2] row_mask:0xf bank_mask:0xf
    v_add_f32_dpp v105, v105, v105 quad_perm:[1,0,3,2] row_mask:0xf bank_mask:0xf
    s_nop 1
    v_add_f32_dpp v104, v104, v104 quad_perm:[2,3,0,1] row_mask:0xf bank_mask:0xf
    v_add_f32_dpp v105, v105, v105 quad_perm:[2,3,0,1] row_mask:0xf bank_mask:0xf
    s_nop 1
    v_add_f32_dpp v104, v104, v104 row_ror:4 row_mask:0xf bank_mask:0xf
    v_add_f32_dpp v105, v105, v105 row_ror:4 row_mask:0xf bank_mask:0xf
    s_nop 1
    v_add_f32_dpp v104, v104, v104 row_ror:8 row_mask:0xf bank_mask:0xf
    v_add_f32_dpp v105, v105, v105 row_ror:8 row_mask:0xf bank_mask:0xf
    v_mov_b32 v106, v104
    v_mov_b32 v107, v105
    s_nop 1
    v_permlane16_swap_b32 v104, v106
    v_permlane16_swap_b32 v105, v107
    s_nop 1
    v_add_f32 v104, v104, v106
    v_add_f32 v105, v105, v107
    v_mov_b32 v106, v104
    v_mov_b32 v107, v105
    s_nop 1
    v_permlane32_swap_b32 v104, v106
    v_permlane32_swap_b32 v105, v107
    s_nop 1
    v_add_f32 v104, v104, v106
    v_add_f32 v105, v105, v107
    v_mul_f32 v104, 0xbfb8aa3b, v104
    v_mul_f32 v105, 0xbfb8aa3b, v105
    v_exp_f32 v104, v104
    v_exp_f32 v105, v105
    s_nop 0
    v_add_f32 v104, 1.0, v104
    v_add_f32 v105, 1.0, v105
    v_rcp_f32 v104, v104
    v_rcp_f32 v105, v105
    s_lshl_b32 s56, s55, 2
    v_mov_b32 v28, 0
    v_cmp_eq_u32 vcc, 0, v1
    s_and_saveexec_b64 s[80:81], vcc
    buffer_store_dwordx2 v[104:105], v28, s[20:23], s56 offen sc1
    s_mov_b64 exec, s[80:81]
    s_cmp_eq_u32 s45, 0
    s_cbranch_scc1 k1_q4
    s_sub_u32 s71, s70, 8
    s_lshl_b32 s71, s71, 13
k1_qpoll:
    buffer_load_dwordx4 v[88:91], v85, s[16:19], s71 offen sc1
    s_waitcnt vmcnt(0)
    v_xor_b32 v28, v89, v88
    v_xor_b32 v29, v91, v90
    v_xor_b32 v28, v28, v236
    v_xor_b32 v29, v29, v236
    v_or_b32 v28, v28, v29
    v_cmp_ne_u32 vcc, 0, v28
    s_nop 3
    s_cmp_eq_u64 vcc, 0
    s_cbranch_scc1 k1_qgo
    s_sleep 4
    s_branch k1_qpoll
k1_qgo:
    v_mov_b32 v89, v90
    ds_write_b64 v84, v[88:89]
    s_waitcnt lgkmcnt(0)
k1_q3:
    s_barrier
    ds_read_b128 v[140:143], v80 offset:0
    ds_read_b128 v[144:147], v81 offset:5728
    ds_read_b128 v[148:151], v81 offset:4928
    ds_read_b128 v[152:155], v81 offset:4128
    ds_read_b128 v[156:159], v81 offset:3328
    ds_read_b128 v[160:163], v81 offset:2528
    ds_read_b128 v[164:167], v81 offset:1728
    ds_read_b128 v[168:171], v81 offset:928
    ds_read_b128 v[172:175], v81 offset:128
    ds_read_b128 v[176:179], v81 offset:5856
    ds_read_b128 v[180:183], v81 offset:5056
    ds_read_b128 v[184:187], v81 offset:4256
    ds_read_b128 v[188:191], v81 offset:3456
    ds_read_b128 v[192:195], v81 offset:2656
    ds_read_b128 v[196:199], v81 offset:1856
    ds_read_b128 v[200:203], v81 offset:1056
    ds_read_b128 v[204:207], v81 offset:256
    s_waitcnt lgkmcnt(8)
    v_dot2_f32_bf16 v208, v140, v144, 0
    v_dot2_f32_bf16 v209, v140, v148, 0
    v_dot2_f32_bf16 v210, v140, v152, 0
    v_dot2_f32_bf16 v211, v140, v156, 0
    v_dot2_f32_bf16 v212, v140, v160, 0
    v_dot2_f32_bf16 v213, v140, v164, 0
    v_dot2_f32_bf16 v214, v140, v168, 0
    v_dot2_f32_bf16 v215, v140, v172, 0
    v_dot2_f32_bf16 v208, v141, v145, v208
    v_dot2_f32_bf16 v209, v141, v149, v209
    v_dot2_f32_bf16 v210, v141, v153, v210
    v_dot2_f32_bf16 v211, v141, v157, v211
    v_dot2_f32_bf16 v212, v141, v161, v212
    v_dot2_f32_bf16 v213, v141, v165, v213
    v_dot2_f32_bf16 v214, v141, v169, v214
    v_dot2_f32_bf16 v215, v141, v173, v215
    v_dot2_f32_bf16 v208, v142, v146, v208
    v_dot2_f32_bf16 v209, v142, v150, v209
    v_dot2_f32_bf16 v210, v142, v154, v210
    v_dot2_f32_bf16 v211, v142, v158, v211
    v_dot2_f32_bf16 v212, v142, v162, v212
    v_dot2_f32_bf16 v213, v142, v166, v213
    v_dot2_f32_bf16 v214, v142, v170, v214
    v_dot2_f32_bf16 v215, v142, v174, v215
    v_dot2_f32_bf16 v208, v143, v147, v208
    v_dot2_f32_bf16 v209, v143, v151, v209
    v_dot2_f32_bf16 v210, v143, v155, v210
    v_dot2_f32_bf16 v211, v143, v159, v211
    v_dot2_f32_bf16 v212, v143, v163, v212
    v_dot2_f32_bf16 v213, v143, v167, v213
    v_dot2_f32_bf16 v214, v143, v171, v214
    v_dot2_f32_bf16 v215, v143, v175, v215
    s_nop 3
    v_add_f32_dpp v208, v208, v208 quad_perm:[1,0,3,2] row_mask:0xf bank_mask:0xf
    v_add_f32_dpp v209, v209, v209 quad_perm:[1,0,3,2] row_mask:0xf bank_mask:0xf
    v_add_f32_dpp v210, v210, v210 quad_perm:[1,0,3,2] row_mask:0xf bank_mask:0xf
    v_add_f32_dpp v211, v211, v211 quad_perm:[1,0,3,2] row_mask:0xf bank_mask:0xf
    v_add_f32_dpp v212, v212, v212 quad_perm:[1,0,3,2] row_mask:0xf bank_mask:0xf
    v_add_f32_dpp v213, v213, v213 quad_perm:[1,0,3,2] row_mask:0xf bank_mask:0xf
    v_add_f32_dpp v214, v214, v214 quad_perm:[1,0,3,2] row_mask:0xf bank_mask:0xf
    v_add_f32_dpp v215, v215, v215 quad_perm:[1,0,3,2] row_mask:0xf bank_mask:0xf
    v_max3_f32 v232, v208, v209, v210
    v_max3_f32 v233, v211, v212, v213
    v_max3_f32 v232, v232, v214, v215
    v_max_f32 v232, v232, v233
    v_mul_f32 v232, s52, v232
    v_fma_f32 v208, v208, s52, -v232
    v_fma_f32 v209, v209, s52, -v232
    v_fma_f32 v210, v210, s52, -v232
    v_fma_f32 v211, v211, s52, -v232
    v_fma_f32 v212, v212, s52, -v232
    v_fma_f32 v213, v213, s52, -v232
    v_fma_f32 v214, v214, s52, -v232
    v_fma_f32 v215, v215, s52, -v232
    v_exp_f32 v208, v208
    v_exp_f32 v209, v209
    v_exp_f32 v210, v210
    v_exp_f32 v211, v211
    v_exp_f32 v212, v212
    v_exp_f32 v213, v213
    v_exp_f32 v214, v214
    v_exp_f32 v215, v215
    s_nop 0
    v_add_f32 v232, v208, v209
    v_add_f32 v233, v210, v211
    v_add_f32 v234, v212, v213
    v_add_f32 v235, v214, v215
    v_add_f32 v232, v232, v233
    v_add_f32 v234, v234, v235
    v_add_f32 v232, v232, v234
    v_rcp_f32 v232, v232
    s_waitcnt lgkmcnt(0)
    v_lshlrev_b32 v224, 16, v176
    v_and_b32 v225, 0xffff0000, v176
    v_lshlrev_b32 v226, 16, v177
    v_and_b32 v227, 0xffff0000, v177
    v_lshlrev_b32 v228, 16, v178
    v_and_b32 v229, 0xffff0000, v178
    v_lshlrev_b32 v230, 16, v179
    v_and_b32 v231, 0xffff0000, v179
    v_mul_f32 v216, v208, v224
    v_mul_f32 v217, v208, v225
    v_mul_f32 v218, v208, v226
    v_mul_f32 v219, v208, v227
    v_mul_f32 v220, v208, v228
    v_mul_f32 v221, v208, v229
    v_mul_f32 v222, v208, v230
    v_mul_f32 v223, v208, v231
    v_lshlrev_b32 v224, 16, v180
    v_and_b32 v225, 0xffff0000, v180
    v_lshlrev_b32 v226, 16, v181
    v_and_b32 v227, 0xffff0000, v181
    v_lshlrev_b32 v228, 16, v182
    v_and_b32 v229, 0xffff0000, v182
    v_lshlrev_b32 v230, 16, v183
    v_and_b32 v231, 0xffff0000, v183
    v_fmac_f32 v216, v209, v224
    v_fmac_f32 v217, v209, v225
    v_fmac_f32 v218, v209, v226
    v_fmac_f32 v219, v209, v227
    v_fmac_f32 v220, v209, v228
    v_fmac_f32 v221, v209, v229
    v_fmac_f32 v222, v209, v230
    v_fmac_f32 v223, v209, v231
    v_lshlrev_b32 v224, 16, v184
    v_and_b32 v225, 0xffff0000, v184
    v_lshlrev_b32 v226, 16, v185
    v_and_b32 v227, 0xffff0000, v185
    v_lshlrev_b32 v228, 16, v186
    v_and_b32 v229, 0xffff0000, v186
    v_lshlrev_b32 v230, 16, v187
    v_and_b32 v231, 0xffff0000, v187
    v_fmac_f32 v216, v210, v224
    v_fmac_f32 v217, v210, v225
    v_fmac_f32 v218, v210, v226
    v_fmac_f32 v219, v210, v227
    v_fmac_f32 v220, v210, v228
    v_fmac_f32 v221, v210, v229
    v_fmac_f32 v222, v210, v230
    v_fmac_f32 v223, v210, v231
    v_lshlrev_b32 v224, 16, v188
    v_and_b32 v225, 0xffff0000, v188
    v_lshlrev_b32 v226, 16, v189
    v_and_b32 v227, 0xffff0000, v189
    v_lshlrev_b32 v228, 16, v190
    v_and_b32 v229, 0xffff0000, v190
    v_lshlrev_b32 v230, 16, v191
    v_and_b32 v231, 0xffff0000, v191
    v_fmac_f32 v216, v211, v224
    v_fmac_f32 v217, v211, v225
    v_fmac_f32 v218, v211, v226
    v_fmac_f32 v219, v211, v227
    v_fmac_f32 v220, v211, v228
    v_fmac_f32 v221, v211, v229
    v_fmac_f32 v222, v211, v230
    v_fmac_f32 v223, v211, v231
    v_lshlrev_b32 v224, 16, v192
    v_and_b32 v225, 0xffff0000, v192
    v_lshlrev_b32 v226, 16, v193
    v_and_b32 v227, 0xffff0000, v193
    v_lshlrev_b32 v228, 16, v194
    v_and_b32 v229, 0xffff0000, v194
    v_lshlrev_b32 v230, 16, v195
    v_and_b32 v231, 0xffff0000, v195
    v_fmac_f32 v216, v212, v224
    v_fmac_f32 v217, v212, v225
    v_fmac_f32 v218, v212, v226
    v_fmac_f32 v219, v212, v227
    v_fmac_f32 v220, v212, v228
    v_fmac_f32 v221, v212, v229
    v_fmac_f32 v222, v212, v230
    v_fmac_f32 v223, v212, v231
    v_lshlrev_b32 v224, 16, v196
    v_and_b32 v225, 0xffff0000, v196
    v_lshlrev_b32 v226, 16, v197
    v_and_b32 v227, 0xffff0000, v197
    v_lshlrev_b32 v228, 16, v198
    v_and_b32 v229, 0xffff0000, v198
    v_lshlrev_b32 v230, 16, v199
    v_and_b32 v231, 0xffff0000, v199
    v_fmac_f32 v216, v213, v224
    v_fmac_f32 v217, v213, v225
    v_fmac_f32 v218, v213, v226
    v_fmac_f32 v219, v213, v227
    v_fmac_f32 v220, v213, v228
    v_fmac_f32 v221, v213, v229
    v_fmac_f32 v222, v213, v230
    v_fmac_f32 v223, v213, v231
    v_lshlrev_b32 v224, 16, v200
    v_and_b32 v225, 0xffff0000, v200
    v_lshlrev_b32 v226, 16, v201
    v_and_b32 v227, 0xffff0000, v201
    v_lshlrev_b32 v228, 16, v202
    v_and_b32 v229, 0xffff0000, v202
    v_lshlrev_b32 v230, 16, v203
    v_and_b32 v231, 0xffff0000, v203
    v_fmac_f32 v216, v214, v224
    v_fmac_f32 v217, v214, v225
    v_fmac_f32 v218, v214, v226
    v_fmac_f32 v219, v214, v227
    v_fmac_f32 v220, v214, v228
    v_fmac_f32 v221, v214, v229
    v_fmac_f32 v222, v214, v230
    v_fmac_f32 v223, v214, v231
    v_lshlrev_b32 v224, 16, v204
    v_and_b32 v225, 0xffff0000, v204
    v_lshlrev_b32 v226, 16, v205
    v_and_b32 v227, 0xffff0000, v205
    v_lshlrev_b32 v228, 16, v206
    v_and_b32 v229, 0xffff0000, v206
    v_lshlrev_b32 v230, 16, v207
    v_and_b32 v231, 0xffff0000, v207
    v_fmac_f32 v216, v215, v224
    v_fmac_f32 v217, v215, v225
    v_fmac_f32 v218, v215, v226
    v_fmac_f32 v219, v215, v227
    v_fmac_f32 v220, v215, v228
    v_fmac_f32 v221, v215, v229
    v_fmac_f32 v222, v215, v230
    v_fmac_f32 v223, v215, v231
    v_mul_f32 v216, v216, v232
    v_mul_f32 v217, v217, v232
    v_mul_f32 v218, v218, v232
    v_mul_f32 v219, v219, v232
    v_mul_f32 v220, v220, v232
    v_mul_f32 v221, v221, v232
    v_mul_f32 v222, v222, v232
    v_mul_f32 v223, v223, v232
    v_cvt_pk_bf16_f32 v140, v216, v217
    v_cvt_pk_bf16_f32 v141, v218, v219
    v_cvt_pk_bf16_f32 v142, v220, v221
    v_cvt_pk_bf16_f32 v143, v222, v223
    s_add_u32 s65, s73, 0
    buffer_store_dwordx4 v[140:143], v83, s[12:15], s65 offen sc1
    s_branch k1_pf
k1_q4:
    ds_read_b128 v[140:143], v80 offset:0
    ds_read_b128 v[144:147], v81 offset:5728
    ds_read_b128 v[148:151], v81 offset:4928
    ds_read_b128 v[152:155], v81 offset:4128
    ds_read_b128 v[156:159], v81 offset:3328
    ds_read_b128 v[160:163], v81 offset:2528
    ds_read_b128 v[164:167], v81 offset:1728
    ds_read_b128 v[168:171], v81 offset:928
    ds_read_b128 v[172:175], v81 offset:128
    ds_read_b128 v[176:179], v81 offset:5856
    ds_read_b128 v[180:183], v81 offset:5056
    ds_read_b128 v[184:187], v81 offset:4256
    ds_read_b128 v[188:191], v81 offset:3456
    ds_read_b128 v[192:195], v81 offset:2656
    ds_read_b128 v[196:199], v81 offset:1856
    ds_read_b128 v[200:203], v81 offset:1056
    ds_read_b128 v[204:207], v81 offset:256
    s_waitcnt lgkmcnt(8)
    v_dot2_f32_bf16 v208, v140, v144, 0
    v_dot2_f32_bf16 v209, v140, v148, 0
    v_dot2_f32_bf16 v210, v140, v152, 0
    v_dot2_f32_bf16 v211, v140, v156, 0
    v_dot2_f32_bf16 v212, v140, v160, 0
    v_dot2_f32_bf16 v213, v140, v164, 0
    v_dot2_f32_bf16 v214, v140, v168, 0
    v_dot2_f32_bf16 v215, v140, v172, 0
    v_dot2_f32_bf16 v208, v141, v145, v208
    v_dot2_f32_bf16 v209, v141, v149, v209
    v_dot2_f32_bf16 v210, v141, v153, v210
    v_dot2_f32_bf16 v211, v141, v157, v211
    v_dot2_f32_bf16 v212, v141, v161, v212
    v_dot2_f32_bf16 v213, v141, v165, v213
    v_dot2_f32_bf16 v214, v141, v169, v214
    v_dot2_f32_bf16 v215, v141, v173, v215
    v_dot2_f32_bf16 v208, v142, v146, v208
    v_dot2_f32_bf16 v209, v142, v150, v209
    v_dot2_f32_bf16 v210, v142, v154, v210
    v_dot2_f32_bf16 v211, v142, v158, v211
    v_dot2_f32_bf16 v212, v142, v162, v212
    v_dot2_f32_bf16 v213, v142, v166, v213
    v_dot2_f32_bf16 v214, v142, v170, v214
    v_dot2_f32_bf16 v215, v142, v174, v215
    v_dot2_f32_bf16 v208, v143, v147, v208
    v_dot2_f32_bf16 v209, v143, v151, v209
    v_dot2_f32_bf16 v210, v143, v155, v210
    v_dot2_f32_bf16 v211, v143, v159, v211
    v_dot2_f32_bf16 v212, v143, v163, v212
    v_dot2_f32_bf16 v213, v143, v167, v213
    v_dot2_f32_bf16 v214, v143, v171, v214
    v_dot2_f32_bf16 v215, v143, v175, v215
    s_nop 3
    v_add_f32_dpp v208, v208, v208 quad_perm:[1,0,3,2] row_mask:0xf bank_mask:0xf
    v_add_f32_dpp v209, v209, v209 quad_perm:[1,0,3,2] row_mask:0xf bank_mask:0xf
    v_add_f32_dpp v210, v210, v210 quad_perm:[1,0,3,2] row_mask:0xf bank_mask:0xf
    v_add_f32_dpp v211, v211, v211 quad_perm:[1,0,3,2] row_mask:0xf bank_mask:0xf
    v_add_f32_dpp v212, v212, v212 quad_perm:[1,0,3,2] row_mask:0xf bank_mask:0xf
    v_add_f32_dpp v213, v213, v213 quad_perm:[1,0,3,2] row_mask:0xf bank_mask:0xf
    v_add_f32_dpp v214, v214, v214 quad_perm:[1,0,3,2] row_mask:0xf bank_mask:0xf
    v_add_f32_dpp v215, v215, v215 quad_perm:[1,0,3,2] row_mask:0xf bank_mask:0xf
    v_mov_b32 v234, 0xff800000
    v_cmp_gt_i32 vcc, 2, v82
    s_nop 1
    v_cndmask_b32 v209, v209, v234, vcc
    v_cmp_gt_i32 vcc, 4, v82
    s_nop 1
    v_cndmask_b32 v210, v210, v234, vcc
    v_cmp_gt_i32 vcc, 6, v82
    s_nop 1
    v_cndmask_b32 v211, v211, v234, vcc
    v_cmp_gt_i32 vcc, 8, v82
    s_nop 1
    v_cndmask_b32 v212, v212, v234, vcc
    v_cmp_gt_i32 vcc, 10, v82
    s_nop 1
    v_cndmask_b32 v213, v213, v234, vcc
    v_cmp_gt_i32 vcc, 12, v82
    s_nop 1
    v_cndmask_b32 v214, v214, v234, vcc
    v_cmp_gt_i32 vcc, 14, v82
    s_nop 1
    v_cndmask_b32 v215, v215, v234, vcc
    v_max3_f32 v232, v208, v209, v210
    v_max3_f32 v233, v211, v212, v213
    v_max3_f32 v232, v232, v214, v215
    v_max_f32 v232, v232, v233
    v_mul_f32 v232, s52, v232
    v_fma_f32 v208, v208, s52, -v232
    v_fma_f32 v209, v209, s52, -v232
    v_fma_f32 v210, v210, s52, -v232
    v_fma_f32 v211, v211, s52, -v232
    v_fma_f32 v212, v212, s52, -v232
    v_fma_f32 v213, v213, s52, -v232
    v_fma_f32 v214, v214, s52, -v232
    v_fma_f32 v215, v215, s52, -v232
    v_exp_f32 v208, v208
    v_exp_f32 v209, v209
    v_exp_f32 v210, v210
    v_exp_f32 v211, v211
    v_exp_f32 v212, v212
    v_exp_f32 v213, v213
    v_exp_f32 v214, v214
    v_exp_f32 v215, v215
    s_nop 0
    v_add_f32 v232, v208, v209
    v_add_f32 v233, v210, v211
    v_add_f32 v234, v212, v213
    v_add_f32 v235, v214, v215
    v_add_f32 v232, v232, v233
    v_add_f32 v234, v234, v235
    v_add_f32 v232, v232, v234
    v_rcp_f32 v232, v232
    s_waitcnt lgkmcnt(0)
    v_lshlrev_b32 v224, 16, v176
    v_and_b32 v225, 0xffff0000, v176
    v_lshlrev_b32 v226, 16, v177
    v_and_b32 v227, 0xffff0000, v177
    v_lshlrev_b32 v228, 16, v178
    v_and_b32 v229, 0xffff0000, v178
    v_lshlrev_b32 v230, 16, v179
    v_and_b32 v231, 0xffff0000, v179
    v_mul_f32 v216, v208, v224
    v_mul_f32 v217, v208, v225
    v_mul_f32 v218, v208, v226
    v_mul_f32 v219, v208, v227
    v_mul_f32 v220, v208, v228
    v_mul_f32 v221, v208, v229
    v_mul_f32 v222, v208, v230
    v_mul_f32 v223, v208, v231
    v_lshlrev_b32 v224, 16, v180
    v_and_b32 v225, 0xffff0000, v180
    v_lshlrev_b32 v226, 16, v181
    v_and_b32 v227, 0xffff0000, v181
    v_lshlrev_b32 v228, 16, v182
    v_and_b32 v229, 0xffff0000, v182
    v_lshlrev_b32 v230, 16, v183
    v_and_b32 v231, 0xffff0000, v183
    v_fmac_f32 v216, v209, v224
    v_fmac_f32 v217, v209, v225
    v_fmac_f32 v218, v209, v226
    v_fmac_f32 v219, v209, v227
    v_fmac_f32 v220, v209, v228
    v_fmac_f32 v221, v209, v229
    v_fmac_f32 v222, v209, v230
    v_fmac_f32 v223, v209, v231
    v_lshlrev_b32 v224, 16, v184
    v_and_b32 v225, 0xffff0000, v184
    v_lshlrev_b32 v226, 16, v185
    v_and_b32 v227, 0xffff0000, v185
    v_lshlrev_b32 v228, 16, v186
    v_and_b32 v229, 0xffff0000, v186
    v_lshlrev_b32 v230, 16, v187
    v_and_b32 v231, 0xffff0000, v187
    v_fmac_f32 v216, v210, v224
    v_fmac_f32 v217, v210, v225
    v_fmac_f32 v218, v210, v226
    v_fmac_f32 v219, v210, v227
    v_fmac_f32 v220, v210, v228
    v_fmac_f32 v221, v210, v229
    v_fmac_f32 v222, v210, v230
    v_fmac_f32 v223, v210, v231
    v_lshlrev_b32 v224, 16, v188
    v_and_b32 v225, 0xffff0000, v188
    v_lshlrev_b32 v226, 16, v189
    v_and_b32 v227, 0xffff0000, v189
    v_lshlrev_b32 v228, 16, v190
    v_and_b32 v229, 0xffff0000, v190
    v_lshlrev_b32 v230, 16, v191
    v_and_b32 v231, 0xffff0000, v191
    v_fmac_f32 v216, v211, v224
    v_fmac_f32 v217, v211, v225
    v_fmac_f32 v218, v211, v226
    v_fmac_f32 v219, v211, v227
    v_fmac_f32 v220, v211, v228
    v_fmac_f32 v221, v211, v229
    v_fmac_f32 v222, v211, v230
    v_fmac_f32 v223, v211, v231
    v_lshlrev_b32 v224, 16, v192
    v_and_b32 v225, 0xffff0000, v192
    v_lshlrev_b32 v226, 16, v193
    v_and_b32 v227, 0xffff0000, v193
    v_lshlrev_b32 v228, 16, v194
    v_and_b32 v229, 0xffff0000, v194
    v_lshlrev_b32 v230, 16, v195
    v_and_b32 v231, 0xffff0000, v195
    v_fmac_f32 v216, v212, v224
    v_fmac_f32 v217, v212, v225
    v_fmac_f32 v218, v212, v226
    v_fmac_f32 v219, v212, v227
    v_fmac_f32 v220, v212, v228
    v_fmac_f32 v221, v212, v229
    v_fmac_f32 v222, v212, v230
    v_fmac_f32 v223, v212, v231
    v_lshlrev_b32 v224, 16, v196
    v_and_b32 v225, 0xffff0000, v196
    v_lshlrev_b32 v226, 16, v197
    v_and_b32 v227, 0xffff0000, v197
    v_lshlrev_b32 v228, 16, v198
    v_and_b32 v229, 0xffff0000, v198
    v_lshlrev_b32 v230, 16, v199
    v_and_b32 v231, 0xffff0000, v199
    v_fmac_f32 v216, v213, v224
    v_fmac_f32 v217, v213, v225
    v_fmac_f32 v218, v213, v226
    v_fmac_f32 v219, v213, v227
    v_fmac_f32 v220, v213, v228
    v_fmac_f32 v221, v213, v229
    v_fmac_f32 v222, v213, v230
    v_fmac_f32 v223, v213, v231
    v_lshlrev_b32 v224, 16, v200
    v_and_b32 v225, 0xffff0000, v200
    v_lshlrev_b32 v226, 16, v201
    v_and_b32 v227, 0xffff0000, v201
    v_lshlrev_b32 v228, 16, v202
    v_and_b32 v229, 0xffff0000, v202
    v_lshlrev_b32 v230, 16, v203
    v_and_b32 v231, 0xffff0000, v203
    v_fmac_f32 v216, v214, v224
    v_fmac_f32 v217, v214, v225
    v_fmac_f32 v218, v214, v226
    v_fmac_f32 v219, v214, v227
    v_fmac_f32 v220, v214, v228
    v_fmac_f32 v221, v214, v229
    v_fmac_f32 v222, v214, v230
    v_fmac_f32 v223, v214, v231
    v_lshlrev_b32 v224, 16, v204
    v_and_b32 v225, 0xffff0000, v204
    v_lshlrev_b32 v226, 16, v205
    v_and_b32 v227, 0xffff0000, v205
    v_lshlrev_b32 v228, 16, v206
    v_and_b32 v229, 0xffff0000, v206
    v_lshlrev_b32 v230, 16, v207
    v_and_b32 v231, 0xffff0000, v207
    v_fmac_f32 v216, v215, v224
    v_fmac_f32 v217, v215, v225
    v_fmac_f32 v218, v215, v226
    v_fmac_f32 v219, v215, v227
    v_fmac_f32 v220, v215, v228
    v_fmac_f32 v221, v215, v229
    v_fmac_f32 v222, v215, v230
    v_fmac_f32 v223, v215, v231
    v_mul_f32 v216, v216, v232
    v_mul_f32 v217, v217, v232
    v_mul_f32 v218, v218, v232
    v_mul_f32 v219, v219, v232
    v_mul_f32 v220, v220, v232
    v_mul_f32 v221, v221, v232
    v_mul_f32 v222, v222, v232
    v_mul_f32 v223, v223, v232
    v_cvt_pk_bf16_f32 v140, v216, v217
    v_cvt_pk_bf16_f32 v141, v218, v219
    v_cvt_pk_bf16_f32 v142, v220, v221
    v_cvt_pk_bf16_f32 v143, v222, v223
    s_add_u32 s65, s73, 0
    buffer_store_dwordx4 v[140:143], v83, s[12:15], s65 offen sc1
k1_pf:
k1_end:
    s_waitcnt vmcnt(0)
k1_nce:
    v_readfirstlane_b32 s82, v236
    s_nop 3
    s_cmp_lg_u32 s82, 0
    s_cbranch_scc1 k1_nde
    s_sleep 2
    buffer_load_dword v236, v237, s[24:27], 0 offen sc1
    s_waitcnt vmcnt(0)
    s_branch k1_nce
k1_nde:
    s_barrier
    s_cmp_lg_u32 s60, 0
    s_cbranch_scc1 k1_fl3
    s_add_u32 s16, s36, 28311552
    s_addc_u32 s17, s37, 0
    s_mov_b32 s18, 0x1000
    s_mov_b32 s19, 0x00020000
    s_cmp_eq_u32 s42, 0
    s_cbranch_scc1 k1_flq
    s_cmp_ge_u32 s46, 4
    s_cbranch_scc1 k1_flz2
    s_lshl_b32 s70, s45, 2
    s_add_u32 s70, s70, s46
    s_lshl_b32 s70, s70, 2
    s_add_u32 s70, s70, 256
    s_branch k1_fl2
k1_flz2:
    s_and_b32 s70, s46, 3
    s_lshl_b32 s70, s70, 4
    s_add_u32 s70, s70, s45
    s_lshl_b32 s70, s70, 2
    s_branch k1_fl2
k1_flq:
    s_lshl_b32 s70, s45, 3
    s_add_u32 s70, s70, s46
    s_lshl_b32 s70, s70, 2
    s_add_u32 s70, s70, 512
k1_fl2:
    v_cmp_eq_u32 vcc, 0, v1
    s_and_saveexec_b64 s[80:81], vcc
    buffer_store_dword v236, v237, s[16:19], s70 offen sc1
    s_mov_b64 exec, s[80:81]
k1_fl3:
    s_branch k34_start
k34_start:
    s_load_dwordx4 s[28:31], s[0:1], 40
    s_load_dwordx2 s[32:33], s[0:1], 16
    s_load_dwordx2 s[34:35], s[0:1], 56
    s_load_dwordx4 s[36:39], s[0:1], 72
    s_load_dwordx2 s[40:41], s[0:1], 88
    v_and_b32 v1, 63, v0
    v_lshrrev_b32 v48, 6, v0
    s_nop 0
    v_readfirstlane_b32 s59, v48
    s_nop 3
    s_and_b32 s60, s59, 3
    s_lshr_b32 s61, s60, 1
    s_and_b32 s62, s60, 1
    s_mul_i32 s63, s60, 2048
    s_mul_i32 s64, s60, 3072
    s_add_u32 s64, s64, 8192
    s_and_b32 s42, s2, 7
    s_lshr_b32 s43, s2, 3
    s_lshr_b32 s44, s42, 1
    s_lshl_b32 s44, s44, 3
    s_lshr_b32 s45, s43, 2
    s_add_u32 s47, s44, s45
    s_and_b32 s45, s42, 1
    s_lshl_b32 s45, s45, 2
    s_and_b32 s46, s43, 3
    s_add_u32 s46, s45, s46
    s_lshl_b32 s44, s47, 6
    s_mul_i32 s45, s46, 96
    s_lshr_b32 s92, s46, 1
    s_lshr_b32 s94, s47, 1
    s_lshl_b32 s93, s94, 4
    s_add_u32 s93, s93, 256
    s_lshl_b32 s92, s92, 6
    s_lshl_b32 s94, s94, 5
    s_add_u32 s94, s94, 512
    s_lshl_b32 s95, s47, 7
    s_add_u32 s95, s95, 1024
    s_waitcnt lgkmcnt(0)
    s_add_u32 s24, s40, 28311552
    s_addc_u32 s25, s41, 0
    s_mov_b32 s26, 0x2000
    s_mov_b32 s27, 0x00020000
    s_cmp_ge_u32 s59, 4
    s_cbranch_scc1 k3_loader
    s_add_u32 s12, s40, 25165824
    s_addc_u32 s13, s41, 0
    s_mov_b32 s14, 0x2c0000
    s_mov_b32 s15, 0x00020000
    s_add_u32 s16, s40, 8388608
    s_addc_u32 s17, s41, 0
    s_mov_b32 s18, 0x560000
    s_mov_b32 s19, 0x00020000
    s_mov_b32 s20, s30
    s_mov_b32 s21, s31
    s_mov_b32 s22, 0x1000
    s_mov_b32 s23, 0x00020000
    s_mov_b32 s4, s36
    s_mov_b32 s5, s37
    s_mov_b32 s6, 0x200000
    s_mov_b32 s7, 0x00020000
    s_add_u32 s8, s40, 24117248
    s_addc_u32 s9, s41, 0
    s_mov_b32 s10, 0x2000
    s_mov_b32 s11, 0x00020000
    v_lshlrev_b32 v48, 2, v1
k3_plz1:
    buffer_load_dword v49, v48, s[24:27], s93 offen sc1
    s_waitcnt vmcnt(0)
    v_cmp_ne_u32 vcc, v49, v236
    s_nop 3
    s_and_b32 s70, vcc_lo, 0xf
    s_cmp_eq_u32 s70, 0
    s_cbranch_scc1 k3_pdz1
    s_sleep 4
    s_branch k3_plz1
k3_pdz1:
    v_and_b32 v48, 15, v1
    s_mul_i32 s65, s61, 32
    s_add_u32 s65, s65, s44
    v_add_u32 v48, s65, v48
    v_lshlrev_b32 v121, 1, v48
    buffer_load_ushort v122, v121, s[20:23], 0 offen offset:0
    buffer_load_ushort v123, v121, s[20:23], 0 offen offset:32
    v_and_b32 v48, 15, v1
    s_mul_i32 s65, s61, 32
    v_add_u32 v48, s65, v48
    v_mul_u32_u24 v120, 400, v48
    v_lshrrev_b32 v48, 4, v1
    v_mul_u32_u24 v48, 16, v48
    v_add_u32 v120, v120, v48
    s_mul_i32 s65, s62, 192
    s_add_u32 s65, s65, 102400
    v_add_u32 v120, s65, v120
    v_add_u32 v48, 0, v1
    s_mov_b32 s65, 5462
    v_mul_lo_u32 v49, v48, s65
    v_lshrrev_b32 v49, 16, v49
    v_mul_u32_u24 v50, 12, v49
    v_sub_u32 v133, v48, v50
    s_mul_i32 s65, s60, 16
    v_add_u32 v49, s65, v49
    v_mul_u32_u24 v124, 400, v49
    v_mul_u32_u24 v50, 32, v133
    v_add_u32 v124, v124, v50
    v_add_u32 v124, 102400, v124
    v_lshlrev_b32 v50, 4, v133
    s_mov_b32 s65, 2752
    v_mul_lo_u32 v127, v49, s65
    v_add_u32 v127, v127, v50
    s_mov_b32 s65, 1408
    v_mul_lo_u32 v130, v49, s65
    v_add_u32 v130, v130, v50
    v_add_u32 v48, 64, v1
    s_mov_b32 s65, 5462
    v_mul_lo_u32 v49, v48, s65
    v_lshrrev_b32 v49, 16, v49
    v_mul_u32_u24 v50, 12, v49
    v_sub_u32 v134, v48, v50
    s_mul_i32 s65, s60, 16
    v_add_u32 v49, s65, v49
    v_mul_u32_u24 v125, 400, v49
    v_mul_u32_u24 v50, 32, v134
    v_add_u32 v125, v125, v50
    v_add_u32 v125, 102400, v125
    v_lshlrev_b32 v50, 4, v134
    s_mov_b32 s65, 2752
    v_mul_lo_u32 v128, v49, s65
    v_add_u32 v128, v128, v50
    s_mov_b32 s65, 1408
    v_mul_lo_u32 v131, v49, s65
    v_add_u32 v131, v131, v50
    v_add_u32 v48, 128, v1
    s_mov_b32 s65, 5462
    v_mul_lo_u32 v49, v48, s65
    v_lshrrev_b32 v49, 16, v49
    v_mul_u32_u24 v50, 12, v49
    v_sub_u32 v135, v48, v50
    s_mul_i32 s65, s60, 16
    v_add_u32 v49, s65, v49
    v_mul_u32_u24 v126, 400, v49
    v_mul_u32_u24 v50, 32, v135
    v_add_u32 v126, v126, v50
    v_add_u32 v126, 102400, v126
    v_lshlrev_b32 v50, 4, v135
    s_mov_b32 s65, 2752
    v_mul_lo_u32 v129, v49, s65
    v_add_u32 v129, v129, v50
    s_mov_b32 s65, 1408
    v_mul_lo_u32 v132, v49, s65
    v_add_u32 v132, v132, v50
    s_mul_i32 s71, s44, 2752
    s_lshl_b32 s72, s45, 1
    s_add_u32 s71, s71, s72
    s_mul_i32 s73, s44, 1408
    s_add_u32 s73, s73, s72
    buffer_load_dwordx4 v[136:139], v127, s[16:19], s71 offen
    buffer_load_dwordx4 v[140:143], v128, s[16:19], s71 offen
    buffer_load_dwordx4 v[144:147], v129, s[16:19], s71 offen
    v_lshrrev_b32 v48, 2, v1
    v_lshlrev_b32 v48, 10, v48
    v_and_b32 v49, 3, v1
    v_lshl_add_u32 v48, v49, 7, v48
    s_and_b32 s78, s42, 1
    s_lshl_b32 s78, s78, 9
    s_cmp_lg_u32 s60, 0
    s_cbranch_scc1 k3_pf1
    s_mov_b32 s52, s32
    s_mov_b32 s53, s33
    s_mov_b32 s54, 0x80000
    s_mov_b32 s55, 0x00020000
    s_lshl_b32 s77, s43, 14
    s_add_u32 s77, s77, s78
    buffer_load_dword v148, v48, s[52:55], s77 offen
    s_branch k3_pf2
k3_pf1:
    s_cmp_ge_u32 s60, 3
    s_cbranch_scc1 k3_pf2
    s_mov_b32 s52, s34
    s_mov_b32 s53, s35
    s_mov_b32 s54, 0xac000
    s_mov_b32 s55, 0x00020000
    s_mul_i32 s77, s43, 22
    s_sub_u32 s76, s60, 1
    s_lshl_b32 s76, s76, 4
    s_add_u32 s77, s77, s76
    s_lshl_b32 s77, s77, 10
    s_add_u32 s77, s77, s78
    buffer_load_dword v148, v48, s[52:55], s77 offen
k3_pf2:
    v_and_b32 v48, 15, v1
    s_mul_i32 s65, s61, 32
    v_add_u32 v48, s65, v48
    v_lshlrev_b32 v48, 7, v48
    v_lshrrev_b32 v49, 4, v1
    v_and_b32 v50, 7, v1
    v_add_u32 v51, 0, v49
    v_xor_b32 v51, v51, v50
    v_lshlrev_b32 v51, 4, v51
    v_add_u32 v6, v48, v51
    v_add_u32 v8, 20480, v6
    v_add_u32 v10, 40960, v6
    v_add_u32 v12, 61440, v6
    v_add_u32 v14, 81920, v6
    v_add_u32 v16, 102400, v6
    v_add_u32 v18, 122880, v6
    v_add_u32 v20, 143360, v6
    v_add_u32 v51, 4, v49
    v_xor_b32 v51, v51, v50
    v_lshlrev_b32 v51, 4, v51
    v_add_u32 v7, v48, v51
    v_add_u32 v9, 20480, v7
    v_add_u32 v11, 40960, v7
    v_add_u32 v13, 61440, v7
    v_add_u32 v15, 81920, v7
    v_add_u32 v17, 102400, v7
    v_add_u32 v19, 122880, v7
    v_add_u32 v21, 143360, v7
    v_lshrrev_b32 v49, 4, v1
    v_bfe_u32 v50, v1, 2, 2
    v_lshl_add_u32 v49, v49, 3, v50
    v_bfe_u32 v51, v49, 3, 1
    v_mul_u32_u24 v49, 192, v49
    v_and_b32 v50, 3, v1
    v_lshl_add_u32 v49, v50, 3, v49
    v_add_u32 v49, 8192, v49
    s_mul_i32 s65, s62, 3
    s_add_u32 s79, s65, 0
    v_xor_b32 v50, s79, v51
    v_lshl_add_u32 v22, v50, 5, v49
    v_add_u32 v25, 20480, v22
    v_add_u32 v28, 40960, v22
    v_add_u32 v31, 61440, v22
    v_add_u32 v34, 81920, v22
    v_add_u32 v37, 102400, v22
    v_add_u32 v40, 122880, v22
    v_add_u32 v43, 143360, v22
    s_add_u32 s79, s65, 1
    v_xor_b32 v50, s79, v51
    v_lshl_add_u32 v23, v50, 5, v49
    v_add_u32 v26, 20480, v23
    v_add_u32 v29, 40960, v23
    v_add_u32 v32, 61440, v23
    v_add_u32 v35, 81920, v23
    v_add_u32 v38, 102400, v23
    v_add_u32 v41, 122880, v23
    v_add_u32 v44, 143360, v23
    s_add_u32 s79, s65, 2
    v_xor_b32 v50, s79, v51
    v_lshl_add_u32 v24, v50, 5, v49
    v_add_u32 v27, 20480, v24
    v_add_u32 v30, 40960, v24
    v_add_u32 v33, 61440, v24
    v_add_u32 v36, 81920, v24
    v_add_u32 v39, 102400, v24
    v_add_u32 v42, 122880, v24
    v_add_u32 v45, 143360, v24
    v_mov_b32 v96, 0
    v_mov_b32 v97, 0
    v_mov_b32 v98, 0
    v_mov_b32 v99, 0
    v_mov_b32 v100, 0
    v_mov_b32 v101, 0
    v_mov_b32 v102, 0
    v_mov_b32 v103, 0
    v_mov_b32 v104, 0
    v_mov_b32 v105, 0
    v_mov_b32 v106, 0
    v_mov_b32 v107, 0
    v_mov_b32 v108, 0
    v_mov_b32 v109, 0
    v_mov_b32 v110, 0
    v_mov_b32 v111, 0
    v_mov_b32 v112, 0
    v_mov_b32 v113, 0
    v_mov_b32 v114, 0
    v_mov_b32 v115, 0
    v_mov_b32 v116, 0
    v_mov_b32 v117, 0
    v_mov_b32 v118, 0
    v_mov_b32 v119, 0
    s_barrier
    ds_read_b128 v[56:59], v6 offset:0
    ds_read_b128 v[60:63], v6 offset:2048
    ds_read_b64_tr_b16 v[72:73], v22 offset:0
    ds_read_b64_tr_b16 v[74:75], v22 offset:768
    ds_read_b64_tr_b16 v[76:77], v23 offset:0
    ds_read_b64_tr_b16 v[78:79], v23 offset:768
    ds_read_b64_tr_b16 v[80:81], v24 offset:0
    ds_read_b64_tr_b16 v[82:83], v24 offset:768
    s_mov_b32 s70, 0
k3_cloop:
    s_barrier
    s_waitcnt lgkmcnt(4)
    v_mfma_f32_16x16x32_bf16 v[96:99], v[72:75], v[56:59], v[96:99]
    ds_read_b128 v[64:67], v7 offset:0
    ds_read_b128 v[68:71], v7 offset:2048
    v_mfma_f32_16x16x32_bf16 v[100:103], v[72:75], v[60:63], v[100:103]
    ds_read_b64_tr_b16 v[84:85], v22 offset:6144
    s_waitcnt lgkmcnt(5)
    v_mfma_f32_16x16x32_bf16 v[104:107], v[76:79], v[56:59], v[104:107]
    ds_read_b64_tr_b16 v[86:87], v22 offset:6912
    v_mfma_f32_16x16x32_bf16 v[108:111], v[76:79], v[60:63], v[108:111]
    ds_read_b64_tr_b16 v[88:89], v23 offset:6144
    ds_read_b64_tr_b16 v[90:91], v23 offset:6912
    s_waitcnt lgkmcnt(6)
    v_mfma_f32_16x16x32_bf16 v[112:115], v[80:83], v[56:59], v[112:115]
    ds_read_b64_tr_b16 v[92:93], v24 offset:6144
    v_mfma_f32_16x16x32_bf16 v[116:119], v[80:83], v[60:63], v[116:119]
    ds_read_b64_tr_b16 v[94:95], v24 offset:6912
    s_waitcnt lgkmcnt(4)
    v_mfma_f32_16x16x32_bf16 v[96:99], v[84:87], v[64:67], v[96:99]
    ds_read_b128 v[56:59], v8 offset:0
    ds_read_b128 v[60:63], v8 offset:2048
    v_mfma_f32_16x16x32_bf16 v[100:103], v[84:87], v[68:71], v[100:103]
    ds_read_b64_tr_b16 v[72:73], v25 offset:0
    s_waitcnt lgkmcnt(5)
    v_mfma_f32_16x16x32_bf16 v[104:107], v[88:91], v[64:67], v[104:107]
    ds_read_b64_tr_b16 v[74:75], v25 offset:768
    v_mfma_f32_16x16x32_bf16 v[108:111], v[88:91], v[68:71], v[108:111]
    ds_read_b64_tr_b16 v[76:77], v26 offset:0
    ds_read_b64_tr_b16 v[78:79], v26 offset:768
    s_waitcnt lgkmcnt(6)
    v_mfma_f32_16x16x32_bf16 v[112:115], v[92:95], v[64:67], v[112:115]
    ds_read_b64_tr_b16 v[80:81], v27 offset:0
    v_mfma_f32_16x16x32_bf16 v[116:119], v[92:95], v[68:71], v[116:119]
    ds_read_b64_tr_b16 v[82:83], v27 offset:768
    s_barrier
    s_waitcnt lgkmcnt(4)
    v_mfma_f32_16x16x32_bf16 v[96:99], v[72:75], v[56:59], v[96:99]
    ds_read_b128 v[64:67], v9 offset:0
    ds_read_b128 v[68:71], v9 offset:2048
    v_mfma_f32_16x16x32_bf16 v[100:103], v[72:75], v[60:63], v[100:103]
    ds_read_b64_tr_b16 v[84:85], v25 offset:6144
    s_waitcnt lgkmcnt(5)
    v_mfma_f32_16x16x32_bf16 v[104:107], v[76:79], v[56:59], v[104:107]
    ds_read_b64_tr_b16 v[86:87], v25 offset:6912
    v_mfma_f32_16x16x32_bf16 v[108:111], v[76:79], v[60:63], v[108:111]
    ds_read_b64_tr_b16 v[88:89], v26 offset:6144
    ds_read_b64_tr_b16 v[90:91], v26 offset:6912
    s_waitcnt lgkmcnt(6)
    v_mfma_f32_16x16x32_bf16 v[112:115], v[80:83], v[56:59], v[112:115]
    ds_read_b64_tr_b16 v[92:93], v27 offset:6144
    v_mfma_f32_16x16x32_bf16 v[116:119], v[80:83], v[60:63], v[116:119]
    ds_read_b64_tr_b16 v[94:95], v27 offset:6912
    s_waitcnt lgkmcnt(4)
    v_mfma_f32_16x16x32_bf16 v[96:99], v[84:87], v[64:67], v[96:99]
    ds_read_b128 v[56:59], v10 offset:0
    ds_read_b128 v[60:63], v10 offset:2048
    v_mfma_f32_16x16x32_bf16 v[100:103], v[84:87], v[68:71], v[100:103]
    ds_read_b64_tr_b16 v[72:73], v28 offset:0
    s_waitcnt lgkmcnt(5)
    v_mfma_f32_16x16x32_bf16 v[104:107], v[88:91], v[64:67], v[104:107]
    ds_read_b64_tr_b16 v[74:75], v28 offset:768
    v_mfma_f32_16x16x32_bf16 v[108:111], v[88:91], v[68:71], v[108:111]
    ds_read_b64_tr_b16 v[76:77], v29 offset:0
    ds_read_b64_tr_b16 v[78:79], v29 offset:768
    s_waitcnt lgkmcnt(6)
    v_mfma_f32_16x16x32_bf16 v[112:115], v[92:95], v[64:67], v[112:115]
    ds_read_b64_tr_b16 v[80:81], v30 offset:0
    v_mfma_f32_16x16x32_bf16 v[116:119], v[92:95], v[68:71], v[116:119]
    ds_read_b64_tr_b16 v[82:83], v30 offset:768
    s_barrier
    s_waitcnt lgkmcnt(4)
    v_mfma_f32_16x16x32_bf16 v[96:99], v[72:75], v[56:59], v[96:99]
    ds_read_b128 v[64:67], v11 offset:0
    ds_read_b128 v[68:71], v11 offset:2048
    v_mfma_f32_16x16x32_bf16 v[100:103], v[72:75], v[60:63], v[100:103]
    ds_read_b64_tr_b16 v[84:85], v28 offset:6144
    s_waitcnt lgkmcnt(5)
    v_mfma_f32_16x16x32_bf16 v[104:107], v[76:79], v[56:59], v[104:107]
    ds_read_b64_tr_b16 v[86:87], v28 offset:6912
    v_mfma_f32_16x16x32_bf16 v[108:111], v[76:79], v[60:63], v[108:111]
    ds_read_b64_tr_b16 v[88:89], v29 offset:6144
    ds_read_b64_tr_b16 v[90:91], v29 offset:6912
    s_waitcnt lgkmcnt(6)
    v_mfma_f32_16x16x32_bf16 v[112:115], v[80:83], v[56:59], v[112:115]
    ds_read_b64_tr_b16 v[92:93], v30 offset:6144
    v_mfma_f32_16x16x32_bf16 v[116:119], v[80:83], v[60:63], v[116:119]
    ds_read_b64_tr_b16 v[94:95], v30 offset:6912
    s_waitcnt lgkmcnt(4)
    v_mfma_f32_16x16x32_bf16 v[96:99], v[84:87], v[64:67], v[96:99]
    ds_read_b128 v[56:59], v12 offset:0
    ds_read_b128 v[60:63], v12 offset:2048
    v_mfma_f32_16x16x32_bf16 v[100:103], v[84:87], v[68:71], v[100:103]
    ds_read_b64_tr_b16 v[72:73], v31 offset:0
    s_waitcnt lgkmcnt(5)
    v_mfma_f32_16x16x32_bf16 v[104:107], v[88:91], v[64:67], v[104:107]
    ds_read_b64_tr_b16 v[74:75], v31 offset:768
    v_mfma_f32_16x16x32_bf16 v[108:111], v[88:91], v[68:71], v[108:111]
    ds_read_b64_tr_b16 v[76:77], v32 offset:0
    ds_read_b64_tr_b16 v[78:79], v32 offset:768
    s_waitcnt lgkmcnt(6)
    v_mfma_f32_16x16x32_bf16 v[112:115], v[92:95], v[64:67], v[112:115]
    ds_read_b64_tr_b16 v[80:81], v33 offset:0
    v_mfma_f32_16x16x32_bf16 v[116:119], v[92:95], v[68:71], v[116:119]
    ds_read_b64_tr_b16 v[82:83], v33 offset:768
    s_barrier
    s_waitcnt lgkmcnt(4)
    v_mfma_f32_16x16x32_bf16 v[96:99], v[72:75], v[56:59], v[96:99]
    ds_read_b128 v[64:67], v13 offset:0
    ds_read_b128 v[68:71], v13 offset:2048
    v_mfma_f32_16x16x32_bf16 v[100:103], v[72:75], v[60:63], v[100:103]
    ds_read_b64_tr_b16 v[84:85], v31 offset:6144
    s_waitcnt lgkmcnt(5)
    v_mfma_f32_16x16x32_bf16 v[104:107], v[76:79], v[56:59], v[104:107]
    ds_read_b64_tr_b16 v[86:87], v31 offset:6912
    v_mfma_f32_16x16x32_bf16 v[108:111], v[76:79], v[60:63], v[108:111]
    ds_read_b64_tr_b16 v[88:89], v32 offset:6144
    ds_read_b64_tr_b16 v[90:91], v32 offset:6912
    s_waitcnt lgkmcnt(6)
    v_mfma_f32_16x16x32_bf16 v[112:115], v[80:83], v[56:59], v[112:115]
    ds_read_b64_tr_b16 v[92:93], v33 offset:6144
    v_mfma_f32_16x16x32_bf16 v[116:119], v[80:83], v[60:63], v[116:119]
    ds_read_b64_tr_b16 v[94:95], v33 offset:6912
    s_waitcnt lgkmcnt(4)
    v_mfma_f32_16x16x32_bf16 v[96:99], v[84:87], v[64:67], v[96:99]
    ds_read_b128 v[56:59], v14 offset:0
    ds_read_b128 v[60:63], v14 offset:2048
    v_mfma_f32_16x16x32_bf16 v[100:103], v[84:87], v[68:71], v[100:103]
    ds_read_b64_tr_b16 v[72:73], v34 offset:0
    s_waitcnt lgkmcnt(5)
    v_mfma_f32_16x16x32_bf16 v[104:107], v[88:91], v[64:67], v[104:107]
    ds_read_b64_tr_b16 v[74:75], v34 offset:768
    v_mfma_f32_16x16x32_bf16 v[108:111], v[88:91], v[68:71], v[108:111]
    ds_read_b64_tr_b16 v[76:77], v35 offset:0
    ds_read_b64_tr_b16 v[78:79], v35 offset:768
    s_waitcnt lgkmcnt(6)
    v_mfma_f32_16x16x32_bf16 v[112:115], v[92:95], v[64:67], v[112:115]
    ds_read_b64_tr_b16 v[80:81], v36 offset:0
    v_mfma_f32_16x16x32_bf16 v[116:119], v[92:95], v[68:71], v[116:119]
    ds_read_b64_tr_b16 v[82:83], v36 offset:768
    s_barrier
    s_waitcnt lgkmcnt(4)
    v_mfma_f32_16x16x32_bf16 v[96:99], v[72:75], v[56:59], v[96:99]
    ds_read_b128 v[64:67], v15 offset:0
    ds_read_b128 v[68:71], v15 offset:2048
    v_mfma_f32_16x16x32_bf16 v[100:103], v[72:75], v[60:63], v[100:103]
    ds_read_b64_tr_b16 v[84:85], v34 offset:6144
    s_waitcnt lgkmcnt(5)
    v_mfma_f32_16x16x32_bf16 v[104:107], v[76:79], v[56:59], v[104:107]
    ds_read_b64_tr_b16 v[86:87], v34 offset:6912
    v_mfma_f32_16x16x32_bf16 v[108:111], v[76:79], v[60:63], v[108:111]
    ds_read_b64_tr_b16 v[88:89], v35 offset:6144
    ds_read_b64_tr_b16 v[90:91], v35 offset:6912
    s_waitcnt lgkmcnt(6)
    v_mfma_f32_16x16x32_bf16 v[112:115], v[80:83], v[56:59], v[112:115]
    ds_read_b64_tr_b16 v[92:93], v36 offset:6144
    v_mfma_f32_16x16x32_bf16 v[116:119], v[80:83], v[60:63], v[116:119]
    ds_read_b64_tr_b16 v[94:95], v36 offset:6912
    s_waitcnt lgkmcnt(4)
    v_mfma_f32_16x16x32_bf16 v[96:99], v[84:87], v[64:67], v[96:99]
    ds_read_b128 v[56:59], v16 offset:0
    ds_read_b128 v[60:63], v16 offset:2048
    v_mfma_f32_16x16x32_bf16 v[100:103], v[84:87], v[68:71], v[100:103]
    ds_read_b64_tr_b16 v[72:73], v37 offset:0
    s_waitcnt lgkmcnt(5)
    v_mfma_f32_16x16x32_bf16 v[104:107], v[88:91], v[64:67], v[104:107]
    ds_read_b64_tr_b16 v[74:75], v37 offset:768
    v_mfma_f32_16x16x32_bf16 v[108:111], v[88:91], v[68:71], v[108:111]
    ds_read_b64_tr_b16 v[76:77], v38 offset:0
    ds_read_b64_tr_b16 v[78:79], v38 offset:768
    s_waitcnt lgkmcnt(6)
    v_mfma_f32_16x16x32_bf16 v[112:115], v[92:95], v[64:67], v[112:115]
    ds_read_b64_tr_b16 v[80:81], v39 offset:0
    v_mfma_f32_16x16x32_bf16 v[116:119], v[92:95], v[68:71], v[116:119]
    ds_read_b64_tr_b16 v[82:83], v39 offset:768
    s_barrier
    s_waitcnt lgkmcnt(4)
    v_mfma_f32_16x16x32_bf16 v[96:99], v[72:75], v[56:59], v[96:99]
    ds_read_b128 v[64:67], v17 offset:0
    ds_read_b128 v[68:71], v17 offset:2048
    v_mfma_f32_16x16x32_bf16 v[100:103], v[72:75], v[60:63], v[100:103]
    ds_read_b64_tr_b16 v[84:85], v37 offset:6144
    s_waitcnt lgkmcnt(5)
    v_mfma_f32_16x16x32_bf16 v[104:107], v[76:79], v[56:59], v[104:107]
    ds_read_b64_tr_b16 v[86:87], v37 offset:6912
    v_mfma_f32_16x16x32_bf16 v[108:111], v[76:79], v[60:63], v[108:111]
    ds_read_b64_tr_b16 v[88:89], v38 offset:6144
    ds_read_b64_tr_b16 v[90:91], v38 offset:6912
    s_waitcnt lgkmcnt(6)
    v_mfma_f32_16x16x32_bf16 v[112:115], v[80:83], v[56:59], v[112:115]
    ds_read_b64_tr_b16 v[92:93], v39 offset:6144
    v_mfma_f32_16x16x32_bf16 v[116:119], v[80:83], v[60:63], v[116:119]
    ds_read_b64_tr_b16 v[94:95], v39 offset:6912
    s_waitcnt lgkmcnt(4)
    v_mfma_f32_16x16x32_bf16 v[96:99], v[84:87], v[64:67], v[96:99]
    ds_read_b128 v[56:59], v18 offset:0
    ds_read_b128 v[60:63], v18 offset:2048
    v_mfma_f32_16x16x32_bf16 v[100:103], v[84:87], v[68:71], v[100:103]
    ds_read_b64_tr_b16 v[72:73], v40 offset:0
    s_waitcnt lgkmcnt(5)
    v_mfma_f32_16x16x32_bf16 v[104:107], v[88:91], v[64:67], v[104:107]
    ds_read_b64_tr_b16 v[74:75], v40 offset:768
    v_mfma_f32_16x16x32_bf16 v[108:111], v[88:91], v[68:71], v[108:111]
    ds_read_b64_tr_b16 v[76:77], v41 offset:0
    ds_read_b64_tr_b16 v[78:79], v41 offset:768
    s_waitcnt lgkmcnt(6)
    v_mfma_f32_16x16x32_bf16 v[112:115], v[92:95], v[64:67], v[112:115]
    ds_read_b64_tr_b16 v[80:81], v42 offset:0
    v_mfma_f32_16x16x32_bf16 v[116:119], v[92:95], v[68:71], v[116:119]
    ds_read_b64_tr_b16 v[82:83], v42 offset:768
    s_barrier
    s_waitcnt lgkmcnt(4)
    v_mfma_f32_16x16x32_bf16 v[96:99], v[72:75], v[56:59], v[96:99]
    ds_read_b128 v[64:67], v19 offset:0
    ds_read_b128 v[68:71], v19 offset:2048
    v_mfma_f32_16x16x32_bf16 v[100:103], v[72:75], v[60:63], v[100:103]
    ds_read_b64_tr_b16 v[84:85], v40 offset:6144
    s_waitcnt lgkmcnt(5)
    v_mfma_f32_16x16x32_bf16 v[104:107], v[76:79], v[56:59], v[104:107]
    ds_read_b64_tr_b16 v[86:87], v40 offset:6912
    v_mfma_f32_16x16x32_bf16 v[108:111], v[76:79], v[60:63], v[108:111]
    ds_read_b64_tr_b16 v[88:89], v41 offset:6144
    ds_read_b64_tr_b16 v[90:91], v41 offset:6912
    s_waitcnt lgkmcnt(6)
    v_mfma_f32_16x16x32_bf16 v[112:115], v[80:83], v[56:59], v[112:115]
    ds_read_b64_tr_b16 v[92:93], v42 offset:6144
    v_mfma_f32_16x16x32_bf16 v[116:119], v[80:83], v[60:63], v[116:119]
    ds_read_b64_tr_b16 v[94:95], v42 offset:6912
    s_waitcnt lgkmcnt(4)
    v_mfma_f32_16x16x32_bf16 v[96:99], v[84:87], v[64:67], v[96:99]
    ds_read_b128 v[56:59], v20 offset:0
    ds_read_b128 v[60:63], v20 offset:2048
    v_mfma_f32_16x16x32_bf16 v[100:103], v[84:87], v[68:71], v[100:103]
    ds_read_b64_tr_b16 v[72:73], v43 offset:0
    s_waitcnt lgkmcnt(5)
    v_mfma_f32_16x16x32_bf16 v[104:107], v[88:91], v[64:67], v[104:107]
    ds_read_b64_tr_b16 v[74:75], v43 offset:768
    v_mfma_f32_16x16x32_bf16 v[108:111], v[88:91], v[68:71], v[108:111]
    ds_read_b64_tr_b16 v[76:77], v44 offset:0
    ds_read_b64_tr_b16 v[78:79], v44 offset:768
    s_waitcnt lgkmcnt(6)
    v_mfma_f32_16x16x32_bf16 v[112:115], v[92:95], v[64:67], v[112:115]
    ds_read_b64_tr_b16 v[80:81], v45 offset:0
    v_mfma_f32_16x16x32_bf16 v[116:119], v[92:95], v[68:71], v[116:119]
    ds_read_b64_tr_b16 v[82:83], v45 offset:768
    s_barrier
    s_waitcnt lgkmcnt(4)
    v_mfma_f32_16x16x32_bf16 v[96:99], v[72:75], v[56:59], v[96:99]
    ds_read_b128 v[64:67], v21 offset:0
    ds_read_b128 v[68:71], v21 offset:2048
    v_mfma_f32_16x16x32_bf16 v[100:103], v[72:75], v[60:63], v[100:103]
    ds_read_b64_tr_b16 v[84:85], v43 offset:6144
    s_waitcnt lgkmcnt(5)
    v_mfma_f32_16x16x32_bf16 v[104:107], v[76:79], v[56:59], v[104:107]
    ds_read_b64_tr_b16 v[86:87], v43 offset:6912
    v_mfma_f32_16x16x32_bf16 v[108:111], v[76:79], v[60:63], v[108:111]
    ds_read_b64_tr_b16 v[88:89], v44 offset:6144
    ds_read_b64_tr_b16 v[90:91], v44 offset:6912
    s_waitcnt lgkmcnt(6)
    v_mfma_f32_16x16x32_bf16 v[112:115], v[80:83], v[56:59], v[112:115]
    ds_read_b64_tr_b16 v[92:93], v45 offset:6144
    v_mfma_f32_16x16x32_bf16 v[116:119], v[80:83], v[60:63], v[116:119]
    ds_read_b64_tr_b16 v[94:95], v45 offset:6912
    s_waitcnt lgkmcnt(4)
    v_mfma_f32_16x16x32_bf16 v[96:99], v[84:87], v[64:67], v[96:99]
    ds_read_b128 v[56:59], v6 offset:0
    ds_read_b128 v[60:63], v6 offset:2048
    v_mfma_f32_16x16x32_bf16 v[100:103], v[84:87], v[68:71], v[100:103]
    ds_read_b64_tr_b16 v[72:73], v22 offset:0
    s_waitcnt lgkmcnt(5)
    v_mfma_f32_16x16x32_bf16 v[104:107], v[88:91], v[64:67], v[104:107]
    ds_read_b64_tr_b16 v[74:75], v22 offset:768
    v_mfma_f32_16x16x32_bf16 v[108:111], v[88:91], v[68:71], v[108:111]
    ds_read_b64_tr_b16 v[76:77], v23 offset:0
    ds_read_b64_tr_b16 v[78:79], v23 offset:768
    s_waitcnt lgkmcnt(6)
    v_mfma_f32_16x16x32_bf16 v[112:115], v[92:95], v[64:67], v[112:115]
    ds_read_b64_tr_b16 v[80:81], v24 offset:0
    v_mfma_f32_16x16x32_bf16 v[116:119], v[92:95], v[68:71], v[116:119]
    ds_read_b64_tr_b16 v[82:83], v24 offset:768
    s_add_u32 s70, s70, 1
    s_cmp_lt_u32 s70, 3
    s_cbranch_scc1 k3_cloop
    s_barrier
    s_waitcnt lgkmcnt(4)
    v_mfma_f32_16x16x32_bf16 v[96:99], v[72:75], v[56:59], v[96:99]
    ds_read_b128 v[64:67], v7 offset:0
    ds_read_b128 v[68:71], v7 offset:2048
    v_mfma_f32_16x16x32_bf16 v[100:103], v[72:75], v[60:63], v[100:103]
    ds_read_b64_tr_b16 v[84:85], v22 offset:6144
    s_waitcnt lgkmcnt(5)
    v_mfma_f32_16x16x32_bf16 v[104:107], v[76:79], v[56:59], v[104:107]
    ds_read_b64_tr_b16 v[86:87], v22 offset:6912
    v_mfma_f32_16x16x32_bf16 v[108:111], v[76:79], v[60:63], v[108:111]
    ds_read_b64_tr_b16 v[88:89], v23 offset:6144
    ds_read_b64_tr_b16 v[90:91], v23 offset:6912
    s_waitcnt lgkmcnt(6)
    v_mfma_f32_16x16x32_bf16 v[112:115], v[80:83], v[56:59], v[112:115]
    ds_read_b64_tr_b16 v[92:93], v24 offset:6144
    v_mfma_f32_16x16x32_bf16 v[116:119], v[80:83], v[60:63], v[116:119]
    ds_read_b64_tr_b16 v[94:95], v24 offset:6912
    s_waitcnt lgkmcnt(4)
    v_mfma_f32_16x16x32_bf16 v[96:99], v[84:87], v[64:67], v[96:99]
    ds_read_b128 v[56:59], v8 offset:0
    ds_read_b128 v[60:63], v8 offset:2048
    v_mfma_f32_16x16x32_bf16 v[100:103], v[84:87], v[68:71], v[100:103]
    ds_read_b64_tr_b16 v[72:73], v25 offset:0
    s_waitcnt lgkmcnt(5)
    v_mfma_f32_16x16x32_bf16 v[104:107], v[88:91], v[64:67], v[104:107]
    ds_read_b64_tr_b16 v[74:75], v25 offset:768
    v_mfma_f32_16x16x32_bf16 v[108:111], v[88:91], v[68:71], v[108:111]
    ds_read_b64_tr_b16 v[76:77], v26 offset:0
    ds_read_b64_tr_b16 v[78:79], v26 offset:768
    s_waitcnt lgkmcnt(6)
    v_mfma_f32_16x16x32_bf16 v[112:115], v[92:95], v[64:67], v[112:115]
    ds_read_b64_tr_b16 v[80:81], v27 offset:0
    v_mfma_f32_16x16x32_bf16 v[116:119], v[92:95], v[68:71], v[116:119]
    ds_read_b64_tr_b16 v[82:83], v27 offset:768
    s_barrier
    s_waitcnt lgkmcnt(4)
    v_mfma_f32_16x16x32_bf16 v[96:99], v[72:75], v[56:59], v[96:99]
    ds_read_b128 v[64:67], v9 offset:0
    ds_read_b128 v[68:71], v9 offset:2048
    v_mfma_f32_16x16x32_bf16 v[100:103], v[72:75], v[60:63], v[100:103]
    ds_read_b64_tr_b16 v[84:85], v25 offset:6144
    s_waitcnt lgkmcnt(5)
    v_mfma_f32_16x16x32_bf16 v[104:107], v[76:79], v[56:59], v[104:107]
    ds_read_b64_tr_b16 v[86:87], v25 offset:6912
    v_mfma_f32_16x16x32_bf16 v[108:111], v[76:79], v[60:63], v[108:111]
    ds_read_b64_tr_b16 v[88:89], v26 offset:6144
    ds_read_b64_tr_b16 v[90:91], v26 offset:6912
    s_waitcnt lgkmcnt(6)
    v_mfma_f32_16x16x32_bf16 v[112:115], v[80:83], v[56:59], v[112:115]
    ds_read_b64_tr_b16 v[92:93], v27 offset:6144
    v_mfma_f32_16x16x32_bf16 v[116:119], v[80:83], v[60:63], v[116:119]
    ds_read_b64_tr_b16 v[94:95], v27 offset:6912
    s_waitcnt lgkmcnt(4)
    v_mfma_f32_16x16x32_bf16 v[96:99], v[84:87], v[64:67], v[96:99]
    ds_read_b128 v[56:59], v10 offset:0
    ds_read_b128 v[60:63], v10 offset:2048
    v_mfma_f32_16x16x32_bf16 v[100:103], v[84:87], v[68:71], v[100:103]
    ds_read_b64_tr_b16 v[72:73], v28 offset:0
    s_waitcnt lgkmcnt(5)
    v_mfma_f32_16x16x32_bf16 v[104:107], v[88:91], v[64:67], v[104:107]
    ds_read_b64_tr_b16 v[74:75], v28 offset:768
    v_mfma_f32_16x16x32_bf16 v[108:111], v[88:91], v[68:71], v[108:111]
    ds_read_b64_tr_b16 v[76:77], v29 offset:0
    ds_read_b64_tr_b16 v[78:79], v29 offset:768
    s_waitcnt lgkmcnt(6)
    v_mfma_f32_16x16x32_bf16 v[112:115], v[92:95], v[64:67], v[112:115]
    ds_read_b64_tr_b16 v[80:81], v30 offset:0
    v_mfma_f32_16x16x32_bf16 v[116:119], v[92:95], v[68:71], v[116:119]
    ds_read_b64_tr_b16 v[82:83], v30 offset:768
    s_barrier
    s_waitcnt lgkmcnt(4)
    v_mfma_f32_16x16x32_bf16 v[96:99], v[72:75], v[56:59], v[96:99]
    ds_read_b128 v[64:67], v11 offset:0
    ds_read_b128 v[68:71], v11 offset:2048
    v_mfma_f32_16x16x32_bf16 v[100:103], v[72:75], v[60:63], v[100:103]
    ds_read_b64_tr_b16 v[84:85], v28 offset:6144
    s_waitcnt lgkmcnt(5)
    v_mfma_f32_16x16x32_bf16 v[104:107], v[76:79], v[56:59], v[104:107]
    ds_read_b64_tr_b16 v[86:87], v28 offset:6912
    v_mfma_f32_16x16x32_bf16 v[108:111], v[76:79], v[60:63], v[108:111]
    ds_read_b64_tr_b16 v[88:89], v29 offset:6144
    ds_read_b64_tr_b16 v[90:91], v29 offset:6912
    s_waitcnt lgkmcnt(6)
    v_mfma_f32_16x16x32_bf16 v[112:115], v[80:83], v[56:59], v[112:115]
    ds_read_b64_tr_b16 v[92:93], v30 offset:6144
    v_mfma_f32_16x16x32_bf16 v[116:119], v[80:83], v[60:63], v[116:119]
    ds_read_b64_tr_b16 v[94:95], v30 offset:6912
    s_waitcnt lgkmcnt(4)
    v_mfma_f32_16x16x32_bf16 v[96:99], v[84:87], v[64:67], v[96:99]
    ds_read_b128 v[56:59], v12 offset:0
    ds_read_b128 v[60:63], v12 offset:2048
    v_mfma_f32_16x16x32_bf16 v[100:103], v[84:87], v[68:71], v[100:103]
    ds_read_b64_tr_b16 v[72:73], v31 offset:0
    s_waitcnt lgkmcnt(5)
    v_mfma_f32_16x16x32_bf16 v[104:107], v[88:91], v[64:67], v[104:107]
    ds_read_b64_tr_b16 v[74:75], v31 offset:768
    v_mfma_f32_16x16x32_bf16 v[108:111], v[88:91], v[68:71], v[108:111]
    ds_read_b64_tr_b16 v[76:77], v32 offset:0
    ds_read_b64_tr_b16 v[78:79], v32 offset:768
    s_waitcnt lgkmcnt(6)
    v_mfma_f32_16x16x32_bf16 v[112:115], v[92:95], v[64:67], v[112:115]
    ds_read_b64_tr_b16 v[80:81], v33 offset:0
    v_mfma_f32_16x16x32_bf16 v[116:119], v[92:95], v[68:71], v[116:119]
    ds_read_b64_tr_b16 v[82:83], v33 offset:768
    s_barrier
    s_waitcnt lgkmcnt(4)
    v_mfma_f32_16x16x32_bf16 v[96:99], v[72:75], v[56:59], v[96:99]
    ds_read_b128 v[64:67], v13 offset:0
    ds_read_b128 v[68:71], v13 offset:2048
    v_mfma_f32_16x16x32_bf16 v[100:103], v[72:75], v[60:63], v[100:103]
    ds_read_b64_tr_b16 v[84:85], v31 offset:6144
    s_waitcnt lgkmcnt(5)
    v_mfma_f32_16x16x32_bf16 v[104:107], v[76:79], v[56:59], v[104:107]
    ds_read_b64_tr_b16 v[86:87], v31 offset:6912
    v_mfma_f32_16x16x32_bf16 v[108:111], v[76:79], v[60:63], v[108:111]
    ds_read_b64_tr_b16 v[88:89], v32 offset:6144
    ds_read_b64_tr_b16 v[90:91], v32 offset:6912
    s_waitcnt lgkmcnt(6)
    v_mfma_f32_16x16x32_bf16 v[112:115], v[80:83], v[56:59], v[112:115]
    ds_read_b64_tr_b16 v[92:93], v33 offset:6144
    v_mfma_f32_16x16x32_bf16 v[116:119], v[80:83], v[60:63], v[116:119]
    ds_read_b64_tr_b16 v[94:95], v33 offset:6912
    s_waitcnt lgkmcnt(4)
    v_mfma_f32_16x16x32_bf16 v[96:99], v[84:87], v[64:67], v[96:99]
    ds_read_b128 v[56:59], v14 offset:0
    ds_read_b128 v[60:63], v14 offset:2048
    v_mfma_f32_16x16x32_bf16 v[100:103], v[84:87], v[68:71], v[100:103]
    ds_read_b64_tr_b16 v[72:73], v34 offset:0
    s_waitcnt lgkmcnt(5)
    v_mfma_f32_16x16x32_bf16 v[104:107], v[88:91], v[64:67], v[104:107]
    ds_read_b64_tr_b16 v[74:75], v34 offset:768
    v_mfma_f32_16x16x32_bf16 v[108:111], v[88:91], v[68:71], v[108:111]
    ds_read_b64_tr_b16 v[76:77], v35 offset:0
    ds_read_b64_tr_b16 v[78:79], v35 offset:768
    s_waitcnt lgkmcnt(6)
    v_mfma_f32_16x16x32_bf16 v[112:115], v[92:95], v[64:67], v[112:115]
    ds_read_b64_tr_b16 v[80:81], v36 offset:0
    v_mfma_f32_16x16x32_bf16 v[116:119], v[92:95], v[68:71], v[116:119]
    ds_read_b64_tr_b16 v[82:83], v36 offset:768
    s_barrier
    s_waitcnt lgkmcnt(4)
    v_mfma_f32_16x16x32_bf16 v[96:99], v[72:75], v[56:59], v[96:99]
    ds_read_b128 v[64:67], v15 offset:0
    ds_read_b128 v[68:71], v15 offset:2048
    v_mfma_f32_16x16x32_bf16 v[100:103], v[72:75], v[60:63], v[100:103]
    ds_read_b64_tr_b16 v[84:85], v34 offset:6144
    s_waitcnt lgkmcnt(5)
    v_mfma_f32_16x16x32_bf16 v[104:107], v[76:79], v[56:59], v[104:107]
    ds_read_b64_tr_b16 v[86:87], v34 offset:6912
    v_mfma_f32_16x16x32_bf16 v[108:111], v[76:79], v[60:63], v[108:111]
    ds_read_b64_tr_b16 v[88:89], v35 offset:6144
    ds_read_b64_tr_b16 v[90:91], v35 offset:6912
    s_waitcnt lgkmcnt(6)
    v_mfma_f32_16x16x32_bf16 v[112:115], v[80:83], v[56:59], v[112:115]
    ds_read_b64_tr_b16 v[92:93], v36 offset:6144
    v_mfma_f32_16x16x32_bf16 v[116:119], v[80:83], v[60:63], v[116:119]
    ds_read_b64_tr_b16 v[94:95], v36 offset:6912
    s_waitcnt lgkmcnt(4)
    v_mfma_f32_16x16x32_bf16 v[96:99], v[84:87], v[64:67], v[96:99]
    ds_read_b128 v[56:59], v16 offset:0
    ds_read_b128 v[60:63], v16 offset:2048
    v_mfma_f32_16x16x32_bf16 v[100:103], v[84:87], v[68:71], v[100:103]
    ds_read_b64_tr_b16 v[72:73], v37 offset:0
    s_waitcnt lgkmcnt(5)
    v_mfma_f32_16x16x32_bf16 v[104:107], v[88:91], v[64:67], v[104:107]
    ds_read_b64_tr_b16 v[74:75], v37 offset:768
    v_mfma_f32_16x16x32_bf16 v[108:111], v[88:91], v[68:71], v[108:111]
    ds_read_b64_tr_b16 v[76:77], v38 offset:0
    ds_read_b64_tr_b16 v[78:79], v38 offset:768
    s_waitcnt lgkmcnt(6)
    v_mfma_f32_16x16x32_bf16 v[112:115], v[92:95], v[64:67], v[112:115]
    ds_read_b64_tr_b16 v[80:81], v39 offset:0
    v_mfma_f32_16x16x32_bf16 v[116:119], v[92:95], v[68:71], v[116:119]
    ds_read_b64_tr_b16 v[82:83], v39 offset:768
    s_barrier
    s_waitcnt lgkmcnt(4)
    v_mfma_f32_16x16x32_bf16 v[96:99], v[72:75], v[56:59], v[96:99]
    ds_read_b128 v[64:67], v17 offset:0
    ds_read_b128 v[68:71], v17 offset:2048
    v_mfma_f32_16x16x32_bf16 v[100:103], v[72:75], v[60:63], v[100:103]
    ds_read_b64_tr_b16 v[84:85], v37 offset:6144
    s_waitcnt lgkmcnt(5)
    v_mfma_f32_16x16x32_bf16 v[104:107], v[76:79], v[56:59], v[104:107]
    ds_read_b64_tr_b16 v[86:87], v37 offset:6912
    v_mfma_f32_16x16x32_bf16 v[108:111], v[76:79], v[60:63], v[108:111]
    ds_read_b64_tr_b16 v[88:89], v38 offset:6144
    ds_read_b64_tr_b16 v[90:91], v38 offset:6912
    s_waitcnt lgkmcnt(6)
    v_mfma_f32_16x16x32_bf16 v[112:115], v[80:83], v[56:59], v[112:115]
    ds_read_b64_tr_b16 v[92:93], v39 offset:6144
    v_mfma_f32_16x16x32_bf16 v[116:119], v[80:83], v[60:63], v[116:119]
    ds_read_b64_tr_b16 v[94:95], v39 offset:6912
    s_waitcnt lgkmcnt(4)
    v_mfma_f32_16x16x32_bf16 v[96:99], v[84:87], v[64:67], v[96:99]
    ds_read_b128 v[56:59], v18 offset:0
    ds_read_b128 v[60:63], v18 offset:2048
    v_mfma_f32_16x16x32_bf16 v[100:103], v[84:87], v[68:71], v[100:103]
    ds_read_b64_tr_b16 v[72:73], v40 offset:0
    s_waitcnt lgkmcnt(5)
    v_mfma_f32_16x16x32_bf16 v[104:107], v[88:91], v[64:67], v[104:107]
    ds_read_b64_tr_b16 v[74:75], v40 offset:768
    v_mfma_f32_16x16x32_bf16 v[108:111], v[88:91], v[68:71], v[108:111]
    ds_read_b64_tr_b16 v[76:77], v41 offset:0
    ds_read_b64_tr_b16 v[78:79], v41 offset:768
    s_waitcnt lgkmcnt(6)
    v_mfma_f32_16x16x32_bf16 v[112:115], v[92:95], v[64:67], v[112:115]
    ds_read_b64_tr_b16 v[80:81], v42 offset:0
    v_mfma_f32_16x16x32_bf16 v[116:119], v[92:95], v[68:71], v[116:119]
    ds_read_b64_tr_b16 v[82:83], v42 offset:768
    s_barrier
    s_waitcnt lgkmcnt(4)
    v_mfma_f32_16x16x32_bf16 v[96:99], v[72:75], v[56:59], v[96:99]
    ds_read_b128 v[64:67], v19 offset:0
    ds_read_b128 v[68:71], v19 offset:2048
    v_mfma_f32_16x16x32_bf16 v[100:103], v[72:75], v[60:63], v[100:103]
    ds_read_b64_tr_b16 v[84:85], v40 offset:6144
    s_waitcnt lgkmcnt(5)
    v_mfma_f32_16x16x32_bf16 v[104:107], v[76:79], v[56:59], v[104:107]
    ds_read_b64_tr_b16 v[86:87], v40 offset:6912
    v_mfma_f32_16x16x32_bf16 v[108:111], v[76:79], v[60:63], v[108:111]
    ds_read_b64_tr_b16 v[88:89], v41 offset:6144
    ds_read_b64_tr_b16 v[90:91], v41 offset:6912
    s_waitcnt lgkmcnt(6)
    v_mfma_f32_16x16x32_bf16 v[112:115], v[80:83], v[56:59], v[112:115]
    ds_read_b64_tr_b16 v[92:93], v42 offset:6144
    v_mfma_f32_16x16x32_bf16 v[116:119], v[80:83], v[60:63], v[116:119]
    ds_read_b64_tr_b16 v[94:95], v42 offset:6912
    s_waitcnt lgkmcnt(4)
    v_mfma_f32_16x16x32_bf16 v[96:99], v[84:87], v[64:67], v[96:99]
    ds_read_b128 v[56:59], v20 offset:0
    ds_read_b128 v[60:63], v20 offset:2048
    v_mfma_f32_16x16x32_bf16 v[100:103], v[84:87], v[68:71], v[100:103]
    ds_read_b64_tr_b16 v[72:73], v43 offset:0
    s_waitcnt lgkmcnt(5)
    v_mfma_f32_16x16x32_bf16 v[104:107], v[88:91], v[64:67], v[104:107]
    ds_read_b64_tr_b16 v[74:75], v43 offset:768
    v_mfma_f32_16x16x32_bf16 v[108:111], v[88:91], v[68:71], v[108:111]
    ds_read_b64_tr_b16 v[76:77], v44 offset:0
    ds_read_b64_tr_b16 v[78:79], v44 offset:768
    s_waitcnt lgkmcnt(6)
    v_mfma_f32_16x16x32_bf16 v[112:115], v[92:95], v[64:67], v[112:115]
    ds_read_b64_tr_b16 v[80:81], v45 offset:0
    v_mfma_f32_16x16x32_bf16 v[116:119], v[92:95], v[68:71], v[116:119]
    ds_read_b64_tr_b16 v[82:83], v45 offset:768
    s_waitcnt lgkmcnt(4)
    v_mfma_f32_16x16x32_bf16 v[96:99], v[72:75], v[56:59], v[96:99]
    ds_read_b128 v[64:67], v21 offset:0
    ds_read_b128 v[68:71], v21 offset:2048
    v_mfma_f32_16x16x32_bf16 v[100:103], v[72:75], v[60:63], v[100:103]
    ds_read_b64_tr_b16 v[84:85], v43 offset:6144
    s_waitcnt lgkmcnt(5)
    v_mfma_f32_16x16x32_bf16 v[104:107], v[76:79], v[56:59], v[104:107]
    ds_read_b64_tr_b16 v[86:87], v43 offset:6912
    v_mfma_f32_16x16x32_bf16 v[108:111], v[76:79], v[60:63], v[108:111]
    ds_read_b64_tr_b16 v[88:89], v44 offset:6144
    ds_read_b64_tr_b16 v[90:91], v44 offset:6912
    s_waitcnt lgkmcnt(6)
    v_mfma_f32_16x16x32_bf16 v[112:115], v[80:83], v[56:59], v[112:115]
    ds_read_b64_tr_b16 v[92:93], v45 offset:6144
    v_mfma_f32_16x16x32_bf16 v[116:119], v[80:83], v[60:63], v[116:119]
    ds_read_b64_tr_b16 v[94:95], v45 offset:6912
    s_waitcnt lgkmcnt(4)
    v_mfma_f32_16x16x32_bf16 v[96:99], v[84:87], v[64:67], v[96:99]
    v_mfma_f32_16x16x32_bf16 v[100:103], v[84:87], v[68:71], v[100:103]
    s_waitcnt lgkmcnt(2)
    v_mfma_f32_16x16x32_bf16 v[104:107], v[88:91], v[64:67], v[104:107]
    v_mfma_f32_16x16x32_bf16 v[108:111], v[88:91], v[68:71], v[108:111]
    s_waitcnt lgkmcnt(0)
    v_mfma_f32_16x16x32_bf16 v[112:115], v[92:95], v[64:67], v[112:115]
    v_mfma_f32_16x16x32_bf16 v[116:119], v[92:95], v[68:71], v[116:119]
    s_waitcnt vmcnt(0)
    v_lshlrev_b32 v122, 16, v122
    v_lshlrev_b32 v123, 16, v123
    v_add_f32 v96, v96, v122
    v_add_f32 v97, v97, v122
    v_add_f32 v98, v98, v122
    v_add_f32 v99, v99, v122
    ds_write_b128 v120, v[96:99] offset:0
    v_add_f32 v100, v100, v123
    v_add_f32 v101, v101, v123
    v_add_f32 v102, v102, v123
    v_add_f32 v103, v103, v123
    ds_write_b128 v120, v[100:103] offset:6400
    v_add_f32 v104, v104, v122
    v_add_f32 v105, v105, v122
    v_add_f32 v106, v106, v122
    v_add_f32 v107, v107, v122
    ds_write_b128 v120, v[104:107] offset:64
    v_add_f32 v108, v108, v123
    v_add_f32 v109, v109, v123
    v_add_f32 v110, v110, v123
    v_add_f32 v111, v111, v123
    ds_write_b128 v120, v[108:111] offset:6464
    v_add_f32 v112, v112, v122
    v_add_f32 v113, v113, v122
    v_add_f32 v114, v114, v122
    v_add_f32 v115, v115, v122
    ds_write_b128 v120, v[112:115] offset:128
    v_add_f32 v116, v116, v123
    v_add_f32 v117, v117, v123
    v_add_f32 v118, v118, v123
    v_add_f32 v119, v119, v123
    ds_write_b128 v120, v[116:119] offset:6528
    s_sub_i32 s70, 688, s45
    s_ashr_i32 s70, s70, 3
    s_add_i32 s74, s70, 2
    v_cmp_gt_i32 s[76:77], s70, v133
    v_cmp_gt_i32 vcc, s74, v133
    s_nop 1
    v_mov_b32 v48, 0x7ff00000
    v_cndmask_b32 v130, v48, v130, vcc
    v_cmp_gt_i32 s[78:79], s70, v134
    v_cmp_gt_i32 vcc, s74, v134
    s_nop 1
    v_mov_b32 v48, 0x7ff00000
    v_cndmask_b32 v131, v48, v131, vcc
    v_cmp_gt_i32 s[80:81], s70, v135
    v_cmp_gt_i32 vcc, s74, v135
    s_nop 1
    v_mov_b32 v48, 0x7ff00000
    v_cndmask_b32 v132, v48, v132, vcc
    s_waitcnt lgkmcnt(0)
    s_barrier
    ds_read_b128 v[96:99], v124
    ds_read_b128 v[100:103], v124 offset:16
    ds_read_b128 v[104:107], v125
    ds_read_b128 v[108:111], v125 offset:16
    ds_read_b128 v[112:115], v126
    ds_read_b128 v[116:119], v126 offset:16
    s_waitcnt vmcnt(0)
    s_waitcnt lgkmcnt(4)
    v_lshlrev_b32 v48, 16, v136
    v_and_b32 v49, 0xffff0000, v136
    v_mul_f32 v96, v96, v48
    v_mul_f32 v97, v97, v49
    v_cvt_pk_bf16_f32 v136, v96, v97
    v_cndmask_b32 v136, 0, v136, s[76:77]
    v_lshlrev_b32 v48, 16, v137
    v_and_b32 v49, 0xffff0000, v137
    v_mul_f32 v98, v98, v48
    v_mul_f32 v99, v99, v49
    v_cvt_pk_bf16_f32 v137, v98, v99
    v_cndmask_b32 v137, 0, v137, s[76:77]
    v_lshlrev_b32 v48, 16, v138
    v_and_b32 v49, 0xffff0000, v138
    v_mul_f32 v100, v100, v48
    v_mul_f32 v101, v101, v49
    v_cvt_pk_bf16_f32 v138, v100, v101
    v_cndmask_b32 v138, 0, v138, s[76:77]
    v_lshlrev_b32 v48, 16, v139
    v_and_b32 v49, 0xffff0000, v139
    v_mul_f32 v102, v102, v48
    v_mul_f32 v103, v103, v49
    v_cvt_pk_bf16_f32 v139, v102, v103
    v_cndmask_b32 v139, 0, v139, s[76:77]
    buffer_store_dwordx4 v[136:139], v130, s[12:15], s73 offen sc1
    s_waitcnt lgkmcnt(2)
    v_lshlrev_b32 v48, 16, v140
    v_and_b32 v49, 0xffff0000, v140
    v_mul_f32 v104, v104, v48
    v_mul_f32 v105, v105, v49
    v_cvt_pk_bf16_f32 v140, v104, v105
    v_cndmask_b32 v140, 0, v140, s[78:79]
    v_lshlrev_b32 v48, 16, v141
    v_and_b32 v49, 0xffff0000, v141
    v_mul_f32 v106, v106, v48
    v_mul_f32 v107, v107, v49
    v_cvt_pk_bf16_f32 v141, v106, v107
    v_cndmask_b32 v141, 0, v141, s[78:79]
    v_lshlrev_b32 v48, 16, v142
    v_and_b32 v49, 0xffff0000, v142
    v_mul_f32 v108, v108, v48
    v_mul_f32 v109, v109, v49
    v_cvt_pk_bf16_f32 v142, v108, v109
    v_cndmask_b32 v142, 0, v142, s[78:79]
    v_lshlrev_b32 v48, 16, v143
    v_and_b32 v49, 0xffff0000, v143
    v_mul_f32 v110, v110, v48
    v_mul_f32 v111, v111, v49
    v_cvt_pk_bf16_f32 v143, v110, v111
    v_cndmask_b32 v143, 0, v143, s[78:79]
    buffer_store_dwordx4 v[140:143], v131, s[12:15], s73 offen sc1
    s_waitcnt lgkmcnt(0)
    v_lshlrev_b32 v48, 16, v144
    v_and_b32 v49, 0xffff0000, v144
    v_mul_f32 v112, v112, v48
    v_mul_f32 v113, v113, v49
    v_cvt_pk_bf16_f32 v144, v112, v113
    v_cndmask_b32 v144, 0, v144, s[80:81]
    v_lshlrev_b32 v48, 16, v145
    v_and_b32 v49, 0xffff0000, v145
    v_mul_f32 v114, v114, v48
    v_mul_f32 v115, v115, v49
    v_cvt_pk_bf16_f32 v145, v114, v115
    v_cndmask_b32 v145, 0, v145, s[80:81]
    v_lshlrev_b32 v48, 16, v146
    v_and_b32 v49, 0xffff0000, v146
    v_mul_f32 v116, v116, v48
    v_mul_f32 v117, v117, v49
    v_cvt_pk_bf16_f32 v146, v116, v117
    v_cndmask_b32 v146, 0, v146, s[80:81]
    v_lshlrev_b32 v48, 16, v147
    v_and_b32 v49, 0xffff0000, v147
    v_mul_f32 v118, v118, v48
    v_mul_f32 v119, v119, v49
    v_cvt_pk_bf16_f32 v147, v118, v119
    v_cndmask_b32 v147, 0, v147, s[80:81]
    buffer_store_dwordx4 v[144:147], v132, s[12:15], s73 offen sc1
    s_waitcnt vmcnt(0)
    s_lshl_b32 s70, s46, 2
    s_add_u32 s70, s70, s60
    s_lshl_b32 s70, s70, 2
    s_add_u32 s70, s70, s95
    v_mov_b32 v49, 0
    v_cmp_eq_u32 vcc, 0, v1
    s_and_saveexec_b64 s[80:81], vcc
    buffer_store_dword v236, v49, s[24:27], s70 offen sc1
    s_mov_b64 exec, s[80:81]
    v_lshlrev_b32 v48, 2, v1
k3_plqc:
    buffer_load_dword v49, v48, s[24:27], s94 offen sc1
    s_waitcnt vmcnt(0)
    v_cmp_ne_u32 vcc, v49, v236
    s_nop 3
    s_and_b32 s70, vcc_lo, 0xff
    s_cmp_eq_u32 s70, 0
    s_cbranch_scc1 k3_pdqc
    s_sleep 4
    s_branch k3_plqc
k3_pdqc:
    v_and_b32 v36, 15, v1
    s_mul_i32 s65, s61, 32
    v_add_u32 v36, s65, v36
    v_lshlrev_b32 v36, 7, v36
    v_lshrrev_b32 v37, 4, v1
    v_and_b32 v38, 7, v1
    v_add_u32 v39, 0, v37
    v_xor_b32 v39, v39, v38
    v_lshlrev_b32 v39, 4, v39
    v_add_u32 v2, v36, v39
    v_add_u32 v4, 20480, v2
    v_add_u32 v6, 40960, v2
    v_add_u32 v8, 61440, v2
    v_add_u32 v10, 81920, v2
    v_add_u32 v12, 102400, v2
    v_add_u32 v14, 122880, v2
    v_add_u32 v16, 143360, v2
    v_add_u32 v39, 4, v37
    v_xor_b32 v39, v39, v38
    v_lshlrev_b32 v39, 4, v39
    v_add_u32 v3, v36, v39
    v_add_u32 v5, 20480, v3
    v_add_u32 v7, 40960, v3
    v_add_u32 v9, 61440, v3
    v_add_u32 v11, 81920, v3
    v_add_u32 v13, 102400, v3
    v_add_u32 v15, 122880, v3
    v_add_u32 v17, 143360, v3
    v_lshrrev_b32 v37, 4, v1
    v_bfe_u32 v38, v1, 2, 2
    v_lshl_add_u32 v37, v37, 3, v38
    v_bfe_u32 v39, v37, 1, 1
    v_bfe_u32 v40, v37, 3, 1
    v_lshl_or_b32 v39, v40, 1, v39
    v_mul_u32_u24 v37, 128, v37
    v_and_b32 v38, 3, v1
    v_lshl_add_u32 v37, v38, 3, v37
    v_add_u32 v37, 8192, v37
    s_mul_i32 s65, s62, 2
    s_add_u32 s79, s65, 0
    v_xor_b32 v38, s79, v39
    v_lshl_add_u32 v18, v38, 5, v37
    v_add_u32 v20, 20480, v18
    v_add_u32 v22, 40960, v18
    v_add_u32 v24, 61440, v18
    v_add_u32 v26, 81920, v18
    v_add_u32 v28, 102400, v18
    v_add_u32 v30, 122880, v18
    v_add_u32 v32, 143360, v18
    s_add_u32 s79, s65, 1
    v_xor_b32 v38, s79, v39
    v_lshl_add_u32 v19, v38, 5, v37
    v_add_u32 v21, 20480, v19
    v_add_u32 v23, 40960, v19
    v_add_u32 v25, 61440, v19
    v_add_u32 v27, 81920, v19
    v_add_u32 v29, 102400, v19
    v_add_u32 v31, 122880, v19
    v_add_u32 v33, 143360, v19
    v_mov_b32 v76, 0
    v_mov_b32 v77, 0
    v_mov_b32 v78, 0
    v_mov_b32 v79, 0
    v_mov_b32 v80, 0
    v_mov_b32 v81, 0
    v_mov_b32 v82, 0
    v_mov_b32 v83, 0
    v_mov_b32 v84, 0
    v_mov_b32 v85, 0
    v_mov_b32 v86, 0
    v_mov_b32 v87, 0
    v_mov_b32 v88, 0
    v_mov_b32 v89, 0
    v_mov_b32 v90, 0
    v_mov_b32 v91, 0
    v_mov_b32 v92, 0
    v_mov_b32 v93, 0
    v_mov_b32 v94, 0
    v_mov_b32 v95, 0
    v_mov_b32 v96, 0
    v_mov_b32 v97, 0
    v_mov_b32 v98, 0
    v_mov_b32 v99, 0
    v_mov_b32 v100, 0
    v_mov_b32 v101, 0
    v_mov_b32 v102, 0
    v_mov_b32 v103, 0
    v_mov_b32 v104, 0
    v_mov_b32 v105, 0
    v_mov_b32 v106, 0
    v_mov_b32 v107, 0
    v_and_b32 v36, 15, v1
    s_mul_i32 s65, s61, 32
    s_add_u32 s65, s65, s44
    v_add_u32 v36, s65, v36
    v_lshlrev_b32 v109, 2, v36
    buffer_load_dword v110, v109, s[8:11], 0 offen offset:0
    buffer_load_dword v111, v109, s[8:11], 0 offen offset:64
    v_and_b32 v36, 15, v1
    s_mul_i32 s65, s61, 32
    v_add_u32 v36, s65, v36
    v_mul_u32_u24 v108, 144, v36
    v_lshrrev_b32 v36, 4, v1
    v_mul_u32_u24 v36, 8, v36
    v_add_u32 v108, v108, v36
    s_mul_i32 s65, s62, 64
    s_add_u32 s65, s65, 61440
    v_add_u32 v108, s65, v108
    v_add_u32 v36, 0, v1
    s_mov_b32 s65, 8192
    v_mul_lo_u32 v37, v36, s65
    v_lshrrev_b32 v37, 16, v37
    v_mul_u32_u24 v38, 8, v37
    v_sub_u32 v114, v36, v38
    s_mul_i32 s65, s60, 16
    v_add_u32 v37, s65, v37
    v_mul_u32_u24 v112, 144, v37
    v_mul_u32_u24 v38, 16, v114
    v_add_u32 v112, v112, v38
    v_add_u32 v112, 61440, v112
    v_lshlrev_b32 v38, 4, v114
    s_mov_b32 s65, 1024
    v_mul_lo_u32 v113, v37, s65
    v_add_u32 v113, v113, v38
    s_lshl_b32 s71, s44, 10
    s_lshl_b32 s72, s46, 7
    s_add_u32 s71, s71, s72
    s_barrier
    ds_read_b128 v[44:47], v2 offset:0
    ds_read_b128 v[48:51], v2 offset:2048
    ds_read_b64_tr_b16 v[60:61], v18 offset:0
    ds_read_b64_tr_b16 v[62:63], v18 offset:512
    ds_read_b64_tr_b16 v[64:65], v19 offset:0
    ds_read_b64_tr_b16 v[66:67], v19 offset:512
    s_barrier
    s_waitcnt lgkmcnt(2)
    v_mfma_f32_16x16x32_bf16 v[76:79], v[60:63], v[44:47], v[76:79]
    ds_read_b128 v[52:55], v3 offset:0
    ds_read_b128 v[56:59], v3 offset:2048
    v_mfma_f32_16x16x32_bf16 v[80:83], v[60:63], v[48:51], v[80:83]
    ds_read_b64_tr_b16 v[68:69], v18 offset:4096
    s_waitcnt lgkmcnt(3)
    v_mfma_f32_16x16x32_bf16 v[84:87], v[64:67], v[44:47], v[84:87]
    ds_read_b64_tr_b16 v[70:71], v18 offset:4608
    ds_read_b64_tr_b16 v[72:73], v19 offset:4096
    v_mfma_f32_16x16x32_bf16 v[88:91], v[64:67], v[48:51], v[88:91]
    ds_read_b64_tr_b16 v[74:75], v19 offset:4608
    s_waitcnt lgkmcnt(2)
    v_mfma_f32_16x16x32_bf16 v[76:79], v[68:71], v[52:55], v[76:79]
    ds_read_b128 v[44:47], v4 offset:0
    ds_read_b128 v[48:51], v4 offset:2048
    v_mfma_f32_16x16x32_bf16 v[80:83], v[68:71], v[56:59], v[80:83]
    ds_read_b64_tr_b16 v[60:61], v20 offset:0
    s_waitcnt lgkmcnt(3)
    v_mfma_f32_16x16x32_bf16 v[84:87], v[72:75], v[52:55], v[84:87]
    ds_read_b64_tr_b16 v[62:63], v20 offset:512
    ds_read_b64_tr_b16 v[64:65], v21 offset:0
    v_mfma_f32_16x16x32_bf16 v[88:91], v[72:75], v[56:59], v[88:91]
    ds_read_b64_tr_b16 v[66:67], v21 offset:512
    s_barrier
    s_waitcnt lgkmcnt(2)
    v_mfma_f32_16x16x32_bf16 v[76:79], v[60:63], v[44:47], v[76:79]
    ds_read_b128 v[52:55], v5 offset:0
    ds_read_b128 v[56:59], v5 offset:2048
    v_mfma_f32_16x16x32_bf16 v[80:83], v[60:63], v[48:51], v[80:83]
    ds_read_b64_tr_b16 v[68:69], v20 offset:4096
    s_waitcnt lgkmcnt(3)
    v_mfma_f32_16x16x32_bf16 v[84:87], v[64:67], v[44:47], v[84:87]
    ds_read_b64_tr_b16 v[70:71], v20 offset:4608
    ds_read_b64_tr_b16 v[72:73], v21 offset:4096
    v_mfma_f32_16x16x32_bf16 v[88:91], v[64:67], v[48:51], v[88:91]
    ds_read_b64_tr_b16 v[74:75], v21 offset:4608
    s_waitcnt lgkmcnt(2)
    v_mfma_f32_16x16x32_bf16 v[76:79], v[68:71], v[52:55], v[76:79]
    ds_read_b128 v[44:47], v6 offset:0
    ds_read_b128 v[48:51], v6 offset:2048
    v_mfma_f32_16x16x32_bf16 v[80:83], v[68:71], v[56:59], v[80:83]
    ds_read_b64_tr_b16 v[60:61], v22 offset:0
    s_waitcnt lgkmcnt(3)
    v_mfma_f32_16x16x32_bf16 v[84:87], v[72:75], v[52:55], v[84:87]
    ds_read_b64_tr_b16 v[62:63], v22 offset:512
    ds_read_b64_tr_b16 v[64:65], v23 offset:0
    v_mfma_f32_16x16x32_bf16 v[88:91], v[72:75], v[56:59], v[88:91]
    ds_read_b64_tr_b16 v[66:67], v23 offset:512
    s_barrier
    s_waitcnt lgkmcnt(2)
    v_mfma_f32_16x16x32_bf16 v[76:79], v[60:63], v[44:47], v[76:79]
    ds_read_b128 v[52:55], v7 offset:0
    ds_read_b128 v[56:59], v7 offset:2048
    v_mfma_f32_16x16x32_bf16 v[80:83], v[60:63], v[48:51], v[80:83]
    ds_read_b64_tr_b16 v[68:69], v22 offset:4096
    s_waitcnt lgkmcnt(3)
    v_mfma_f32_16x16x32_bf16 v[84:87], v[64:67], v[44:47], v[84:87]
    ds_read_b64_tr_b16 v[70:71], v22 offset:4608
    ds_read_b64_tr_b16 v[72:73], v23 offset:4096
    v_mfma_f32_16x16x32_bf16 v[88:91], v[64:67], v[48:51], v[88:91]
    ds_read_b64_tr_b16 v[74:75], v23 offset:4608
    s_waitcnt lgkmcnt(2)
    v_mfma_f32_16x16x32_bf16 v[76:79], v[68:71], v[52:55], v[76:79]
    ds_read_b128 v[44:47], v8 offset:0
    ds_read_b128 v[48:51], v8 offset:2048
    v_mfma_f32_16x16x32_bf16 v[80:83], v[68:71], v[56:59], v[80:83]
    ds_read_b64_tr_b16 v[60:61], v24 offset:0
    s_waitcnt lgkmcnt(3)
    v_mfma_f32_16x16x32_bf16 v[84:87], v[72:75], v[52:55], v[84:87]
    ds_read_b64_tr_b16 v[62:63], v24 offset:512
    ds_read_b64_tr_b16 v[64:65], v25 offset:0
    v_mfma_f32_16x16x32_bf16 v[88:91], v[72:75], v[56:59], v[88:91]
    ds_read_b64_tr_b16 v[66:67], v25 offset:512
    s_barrier
    s_waitcnt lgkmcnt(2)
    v_mfma_f32_16x16x32_bf16 v[76:79], v[60:63], v[44:47], v[76:79]
    ds_read_b128 v[52:55], v9 offset:0
    ds_read_b128 v[56:59], v9 offset:2048
    v_mfma_f32_16x16x32_bf16 v[80:83], v[60:63], v[48:51], v[80:83]
    ds_read_b64_tr_b16 v[68:69], v24 offset:4096
    s_waitcnt lgkmcnt(3)
    v_mfma_f32_16x16x32_bf16 v[84:87], v[64:67], v[44:47], v[84:87]
    ds_read_b64_tr_b16 v[70:71], v24 offset:4608
    ds_read_b64_tr_b16 v[72:73], v25 offset:4096
    v_mfma_f32_16x16x32_bf16 v[88:91], v[64:67], v[48:51], v[88:91]
    ds_read_b64_tr_b16 v[74:75], v25 offset:4608
    s_waitcnt lgkmcnt(2)
    v_mfma_f32_16x16x32_bf16 v[76:79], v[68:71], v[52:55], v[76:79]
    ds_read_b128 v[44:47], v10 offset:0
    ds_read_b128 v[48:51], v10 offset:2048
    v_mfma_f32_16x16x32_bf16 v[80:83], v[68:71], v[56:59], v[80:83]
    ds_read_b64_tr_b16 v[60:61], v26 offset:0
    s_waitcnt lgkmcnt(3)
    v_mfma_f32_16x16x32_bf16 v[84:87], v[72:75], v[52:55], v[84:87]
    ds_read_b64_tr_b16 v[62:63], v26 offset:512
    ds_read_b64_tr_b16 v[64:65], v27 offset:0
    v_mfma_f32_16x16x32_bf16 v[88:91], v[72:75], v[56:59], v[88:91]
    ds_read_b64_tr_b16 v[66:67], v27 offset:512
    s_barrier
    s_waitcnt lgkmcnt(2)
    v_mfma_f32_16x16x32_bf16 v[76:79], v[60:63], v[44:47], v[76:79]
    ds_read_b128 v[52:55], v11 offset:0
    ds_read_b128 v[56:59], v11 offset:2048
    v_mfma_f32_16x16x32_bf16 v[80:83], v[60:63], v[48:51], v[80:83]
    ds_read_b64_tr_b16 v[68:69], v26 offset:4096
    s_waitcnt lgkmcnt(3)
    v_mfma_f32_16x16x32_bf16 v[84:87], v[64:67], v[44:47], v[84:87]
    ds_read_b64_tr_b16 v[70:71], v26 offset:4608
    ds_read_b64_tr_b16 v[72:73], v27 offset:4096
    v_mfma_f32_16x16x32_bf16 v[88:91], v[64:67], v[48:51], v[88:91]
    ds_read_b64_tr_b16 v[74:75], v27 offset:4608
    s_waitcnt lgkmcnt(2)
    v_mfma_f32_16x16x32_bf16 v[76:79], v[68:71], v[52:55], v[76:79]
    ds_read_b128 v[44:47], v12 offset:0
    ds_read_b128 v[48:51], v12 offset:2048
    v_mfma_f32_16x16x32_bf16 v[80:83], v[68:71], v[56:59], v[80:83]
    ds_read_b64_tr_b16 v[60:61], v28 offset:0
    s_waitcnt lgkmcnt(3)
    v_mfma_f32_16x16x32_bf16 v[84:87], v[72:75], v[52:55], v[84:87]
    ds_read_b64_tr_b16 v[62:63], v28 offset:512
    ds_read_b64_tr_b16 v[64:65], v29 offset:0
    v_mfma_f32_16x16x32_bf16 v[88:91], v[72:75], v[56:59], v[88:91]
    ds_read_b64_tr_b16 v[66:67], v29 offset:512
    s_barrier
    s_waitcnt lgkmcnt(2)
    v_mfma_f32_16x16x32_bf16 v[76:79], v[60:63], v[44:47], v[76:79]
    ds_read_b128 v[52:55], v13 offset:0
    ds_read_b128 v[56:59], v13 offset:2048
    v_mfma_f32_16x16x32_bf16 v[80:83], v[60:63], v[48:51], v[80:83]
    ds_read_b64_tr_b16 v[68:69], v28 offset:4096
    s_waitcnt lgkmcnt(3)
    v_mfma_f32_16x16x32_bf16 v[84:87], v[64:67], v[44:47], v[84:87]
    ds_read_b64_tr_b16 v[70:71], v28 offset:4608
    ds_read_b64_tr_b16 v[72:73], v29 offset:4096
    v_mfma_f32_16x16x32_bf16 v[88:91], v[64:67], v[48:51], v[88:91]
    ds_read_b64_tr_b16 v[74:75], v29 offset:4608
    s_waitcnt lgkmcnt(2)
    v_mfma_f32_16x16x32_bf16 v[76:79], v[68:71], v[52:55], v[76:79]
    ds_read_b128 v[44:47], v14 offset:0
    ds_read_b128 v[48:51], v14 offset:2048
    v_mfma_f32_16x16x32_bf16 v[80:83], v[68:71], v[56:59], v[80:83]
    ds_read_b64_tr_b16 v[60:61], v30 offset:0
    s_waitcnt lgkmcnt(3)
    v_mfma_f32_16x16x32_bf16 v[84:87], v[72:75], v[52:55], v[84:87]
    ds_read_b64_tr_b16 v[62:63], v30 offset:512
    ds_read_b64_tr_b16 v[64:65], v31 offset:0
    v_mfma_f32_16x16x32_bf16 v[88:91], v[72:75], v[56:59], v[88:91]
    ds_read_b64_tr_b16 v[66:67], v31 offset:512
    s_barrier
    s_waitcnt lgkmcnt(2)
    v_mfma_f32_16x16x32_bf16 v[76:79], v[60:63], v[44:47], v[76:79]
    ds_read_b128 v[52:55], v15 offset:0
    ds_read_b128 v[56:59], v15 offset:2048
    v_mfma_f32_16x16x32_bf16 v[80:83], v[60:63], v[48:51], v[80:83]
    ds_read_b64_tr_b16 v[68:69], v30 offset:4096
    s_waitcnt lgkmcnt(3)
    v_mfma_f32_16x16x32_bf16 v[84:87], v[64:67], v[44:47], v[84:87]
    ds_read_b64_tr_b16 v[70:71], v30 offset:4608
    ds_read_b64_tr_b16 v[72:73], v31 offset:4096
    v_mfma_f32_16x16x32_bf16 v[88:91], v[64:67], v[48:51], v[88:91]
    ds_read_b64_tr_b16 v[74:75], v31 offset:4608
    s_waitcnt lgkmcnt(2)
    v_mfma_f32_16x16x32_bf16 v[76:79], v[68:71], v[52:55], v[76:79]
    ds_read_b128 v[44:47], v16 offset:0
    ds_read_b128 v[48:51], v16 offset:2048
    v_mfma_f32_16x16x32_bf16 v[80:83], v[68:71], v[56:59], v[80:83]
    ds_read_b64_tr_b16 v[60:61], v32 offset:0
    s_waitcnt lgkmcnt(3)
    v_mfma_f32_16x16x32_bf16 v[84:87], v[72:75], v[52:55], v[84:87]
    ds_read_b64_tr_b16 v[62:63], v32 offset:512
    ds_read_b64_tr_b16 v[64:65], v33 offset:0
    v_mfma_f32_16x16x32_bf16 v[88:91], v[72:75], v[56:59], v[88:91]
    ds_read_b64_tr_b16 v[66:67], v33 offset:512
    s_barrier
    s_waitcnt lgkmcnt(2)
    v_mfma_f32_16x16x32_bf16 v[76:79], v[60:63], v[44:47], v[76:79]
    ds_read_b128 v[52:55], v17 offset:0
    ds_read_b128 v[56:59], v17 offset:2048
    v_mfma_f32_16x16x32_bf16 v[80:83], v[60:63], v[48:51], v[80:83]
    ds_read_b64_tr_b16 v[68:69], v32 offset:4096
    s_waitcnt lgkmcnt(3)
    v_mfma_f32_16x16x32_bf16 v[84:87], v[64:67], v[44:47], v[84:87]
    ds_read_b64_tr_b16 v[70:71], v32 offset:4608
    ds_read_b64_tr_b16 v[72:73], v33 offset:4096
    v_mfma_f32_16x16x32_bf16 v[88:91], v[64:67], v[48:51], v[88:91]
    ds_read_b64_tr_b16 v[74:75], v33 offset:4608
    s_waitcnt lgkmcnt(2)
    v_mfma_f32_16x16x32_bf16 v[76:79], v[68:71], v[52:55], v[76:79]
    ds_read_b128 v[44:47], v2 offset:0
    ds_read_b128 v[48:51], v2 offset:2048
    v_mfma_f32_16x16x32_bf16 v[80:83], v[68:71], v[56:59], v[80:83]
    ds_read_b64_tr_b16 v[60:61], v18 offset:0
    s_waitcnt lgkmcnt(3)
    v_mfma_f32_16x16x32_bf16 v[84:87], v[72:75], v[52:55], v[84:87]
    ds_read_b64_tr_b16 v[62:63], v18 offset:512
    ds_read_b64_tr_b16 v[64:65], v19 offset:0
    v_mfma_f32_16x16x32_bf16 v[88:91], v[72:75], v[56:59], v[88:91]
    ds_read_b64_tr_b16 v[66:67], v19 offset:512
    s_barrier
    s_waitcnt lgkmcnt(2)
    v_mfma_f32_16x16x32_bf16 v[92:95], v[60:63], v[44:47], v[92:95]
    ds_read_b128 v[52:55], v3 offset:0
    ds_read_b128 v[56:59], v3 offset:2048
    v_mfma_f32_16x16x32_bf16 v[96:99], v[60:63], v[48:51], v[96:99]
    ds_read_b64_tr_b16 v[68:69], v18 offset:4096
    s_waitcnt lgkmcnt(3)
    v_mfma_f32_16x16x32_bf16 v[100:103], v[64:67], v[44:47], v[100:103]
    ds_read_b64_tr_b16 v[70:71], v18 offset:4608
    ds_read_b64_tr_b16 v[72:73], v19 offset:4096
    v_mfma_f32_16x16x32_bf16 v[104:107], v[64:67], v[48:51], v[104:107]
    ds_read_b64_tr_b16 v[74:75], v19 offset:4608
    s_waitcnt lgkmcnt(2)
    v_mfma_f32_16x16x32_bf16 v[92:95], v[68:71], v[52:55], v[92:95]
    ds_read_b128 v[44:47], v4 offset:0
    ds_read_b128 v[48:51], v4 offset:2048
    v_mfma_f32_16x16x32_bf16 v[96:99], v[68:71], v[56:59], v[96:99]
    ds_read_b64_tr_b16 v[60:61], v20 offset:0
    s_waitcnt lgkmcnt(3)
    v_mfma_f32_16x16x32_bf16 v[100:103], v[72:75], v[52:55], v[100:103]
    ds_read_b64_tr_b16 v[62:63], v20 offset:512
    ds_read_b64_tr_b16 v[64:65], v21 offset:0
    v_mfma_f32_16x16x32_bf16 v[104:107], v[72:75], v[56:59], v[104:107]
    ds_read_b64_tr_b16 v[66:67], v21 offset:512
    s_barrier
    s_waitcnt lgkmcnt(2)
    v_mfma_f32_16x16x32_bf16 v[92:95], v[60:63], v[44:47], v[92:95]
    ds_read_b128 v[52:55], v5 offset:0
    ds_read_b128 v[56:59], v5 offset:2048
    v_mfma_f32_16x16x32_bf16 v[96:99], v[60:63], v[48:51], v[96:99]
    ds_read_b64_tr_b16 v[68:69], v20 offset:4096
    s_waitcnt lgkmcnt(3)
    v_mfma_f32_16x16x32_bf16 v[100:103], v[64:67], v[44:47], v[100:103]
    ds_read_b64_tr_b16 v[70:71], v20 offset:4608
    ds_read_b64_tr_b16 v[72:73], v21 offset:4096
    v_mfma_f32_16x16x32_bf16 v[104:107], v[64:67], v[48:51], v[104:107]
    ds_read_b64_tr_b16 v[74:75], v21 offset:4608
    s_waitcnt lgkmcnt(2)
    v_mfma_f32_16x16x32_bf16 v[92:95], v[68:71], v[52:55], v[92:95]
    ds_read_b128 v[44:47], v6 offset:0
    ds_read_b128 v[48:51], v6 offset:2048
    v_mfma_f32_16x16x32_bf16 v[96:99], v[68:71], v[56:59], v[96:99]
    ds_read_b64_tr_b16 v[60:61], v22 offset:0
    s_waitcnt lgkmcnt(3)
    v_mfma_f32_16x16x32_bf16 v[100:103], v[72:75], v[52:55], v[100:103]
    ds_read_b64_tr_b16 v[62:63], v22 offset:512
    ds_read_b64_tr_b16 v[64:65], v23 offset:0
    v_mfma_f32_16x16x32_bf16 v[104:107], v[72:75], v[56:59], v[104:107]
    ds_read_b64_tr_b16 v[66:67], v23 offset:512
    s_barrier
    s_waitcnt lgkmcnt(2)
    v_mfma_f32_16x16x32_bf16 v[92:95], v[60:63], v[44:47], v[92:95]
    ds_read_b128 v[52:55], v7 offset:0
    ds_read_b128 v[56:59], v7 offset:2048
    v_mfma_f32_16x16x32_bf16 v[96:99], v[60:63], v[48:51], v[96:99]
    ds_read_b64_tr_b16 v[68:69], v22 offset:4096
    s_waitcnt lgkmcnt(3)
    v_mfma_f32_16x16x32_bf16 v[100:103], v[64:67], v[44:47], v[100:103]
    ds_read_b64_tr_b16 v[70:71], v22 offset:4608
    ds_read_b64_tr_b16 v[72:73], v23 offset:4096
    v_mfma_f32_16x16x32_bf16 v[104:107], v[64:67], v[48:51], v[104:107]
    ds_read_b64_tr_b16 v[74:75], v23 offset:4608
    s_waitcnt lgkmcnt(2)
    v_mfma_f32_16x16x32_bf16 v[92:95], v[68:71], v[52:55], v[92:95]
    ds_read_b128 v[44:47], v8 offset:0
    ds_read_b128 v[48:51], v8 offset:2048
    v_mfma_f32_16x16x32_bf16 v[96:99], v[68:71], v[56:59], v[96:99]
    ds_read_b64_tr_b16 v[60:61], v24 offset:0
    s_waitcnt lgkmcnt(3)
    v_mfma_f32_16x16x32_bf16 v[100:103], v[72:75], v[52:55], v[100:103]
    ds_read_b64_tr_b16 v[62:63], v24 offset:512
    ds_read_b64_tr_b16 v[64:65], v25 offset:0
    v_mfma_f32_16x16x32_bf16 v[104:107], v[72:75], v[56:59], v[104:107]
    ds_read_b64_tr_b16 v[66:67], v25 offset:512
    s_barrier
    s_waitcnt lgkmcnt(2)
    v_mfma_f32_16x16x32_bf16 v[92:95], v[60:63], v[44:47], v[92:95]
    ds_read_b128 v[52:55], v9 offset:0
    ds_read_b128 v[56:59], v9 offset:2048
    v_mfma_f32_16x16x32_bf16 v[96:99], v[60:63], v[48:51], v[96:99]
    ds_read_b64_tr_b16 v[68:69], v24 offset:4096
    s_waitcnt lgkmcnt(3)
    v_mfma_f32_16x16x32_bf16 v[100:103], v[64:67], v[44:47], v[100:103]
    ds_read_b64_tr_b16 v[70:71], v24 offset:4608
    ds_read_b64_tr_b16 v[72:73], v25 offset:4096
    v_mfma_f32_16x16x32_bf16 v[104:107], v[64:67], v[48:51], v[104:107]
    ds_read_b64_tr_b16 v[74:75], v25 offset:4608
    s_waitcnt lgkmcnt(2)
    v_mfma_f32_16x16x32_bf16 v[92:95], v[68:71], v[52:55], v[92:95]
    ds_read_b128 v[44:47], v10 offset:0
    ds_read_b128 v[48:51], v10 offset:2048
    v_mfma_f32_16x16x32_bf16 v[96:99], v[68:71], v[56:59], v[96:99]
    ds_read_b64_tr_b16 v[60:61], v26 offset:0
    s_waitcnt lgkmcnt(3)
    v_mfma_f32_16x16x32_bf16 v[100:103], v[72:75], v[52:55], v[100:103]
    ds_read_b64_tr_b16 v[62:63], v26 offset:512
    ds_read_b64_tr_b16 v[64:65], v27 offset:0
    v_mfma_f32_16x16x32_bf16 v[104:107], v[72:75], v[56:59], v[104:107]
    ds_read_b64_tr_b16 v[66:67], v27 offset:512
    s_barrier
    s_waitcnt lgkmcnt(2)
    v_mfma_f32_16x16x32_bf16 v[92:95], v[60:63], v[44:47], v[92:95]
    ds_read_b128 v[52:55], v11 offset:0
    ds_read_b128 v[56:59], v11 offset:2048
    v_mfma_f32_16x16x32_bf16 v[96:99], v[60:63], v[48:51], v[96:99]
    ds_read_b64_tr_b16 v[68:69], v26 offset:4096
    s_waitcnt lgkmcnt(3)
    v_mfma_f32_16x16x32_bf16 v[100:103], v[64:67], v[44:47], v[100:103]
    ds_read_b64_tr_b16 v[70:71], v26 offset:4608
    ds_read_b64_tr_b16 v[72:73], v27 offset:4096
    v_mfma_f32_16x16x32_bf16 v[104:107], v[64:67], v[48:51], v[104:107]
    ds_read_b64_tr_b16 v[74:75], v27 offset:4608
    s_waitcnt lgkmcnt(2)
    v_mfma_f32_16x16x32_bf16 v[92:95], v[68:71], v[52:55], v[92:95]
    ds_read_b128 v[44:47], v12 offset:0
    ds_read_b128 v[48:51], v12 offset:2048
    v_mfma_f32_16x16x32_bf16 v[96:99], v[68:71], v[56:59], v[96:99]
    ds_read_b64_tr_b16 v[60:61], v28 offset:0
    s_waitcnt lgkmcnt(3)
    v_mfma_f32_16x16x32_bf16 v[100:103], v[72:75], v[52:55], v[100:103]
    ds_read_b64_tr_b16 v[62:63], v28 offset:512
    ds_read_b64_tr_b16 v[64:65], v29 offset:0
    v_mfma_f32_16x16x32_bf16 v[104:107], v[72:75], v[56:59], v[104:107]
    ds_read_b64_tr_b16 v[66:67], v29 offset:512
    s_barrier
    s_waitcnt lgkmcnt(2)
    v_mfma_f32_16x16x32_bf16 v[92:95], v[60:63], v[44:47], v[92:95]
    ds_read_b128 v[52:55], v13 offset:0
    ds_read_b128 v[56:59], v13 offset:2048
    v_mfma_f32_16x16x32_bf16 v[96:99], v[60:63], v[48:51], v[96:99]
    ds_read_b64_tr_b16 v[68:69], v28 offset:4096
    s_waitcnt lgkmcnt(3)
    v_mfma_f32_16x16x32_bf16 v[100:103], v[64:67], v[44:47], v[100:103]
    ds_read_b64_tr_b16 v[70:71], v28 offset:4608
    ds_read_b64_tr_b16 v[72:73], v29 offset:4096
    v_mfma_f32_16x16x32_bf16 v[104:107], v[64:67], v[48:51], v[104:107]
    ds_read_b64_tr_b16 v[74:75], v29 offset:4608
    s_waitcnt lgkmcnt(2)
    v_mfma_f32_16x16x32_bf16 v[92:95], v[68:71], v[52:55], v[92:95]
    ds_read_b128 v[44:47], v14 offset:0
    ds_read_b128 v[48:51], v14 offset:2048
    v_mfma_f32_16x16x32_bf16 v[96:99], v[68:71], v[56:59], v[96:99]
    ds_read_b64_tr_b16 v[60:61], v30 offset:0
    s_waitcnt lgkmcnt(3)
    v_mfma_f32_16x16x32_bf16 v[100:103], v[72:75], v[52:55], v[100:103]
    ds_read_b64_tr_b16 v[62:63], v30 offset:512
    ds_read_b64_tr_b16 v[64:65], v31 offset:0
    v_mfma_f32_16x16x32_bf16 v[104:107], v[72:75], v[56:59], v[104:107]
    ds_read_b64_tr_b16 v[66:67], v31 offset:512
    s_barrier
    s_waitcnt lgkmcnt(2)
    v_mfma_f32_16x16x32_bf16 v[92:95], v[60:63], v[44:47], v[92:95]
    ds_read_b128 v[52:55], v15 offset:0
    ds_read_b128 v[56:59], v15 offset:2048
    v_mfma_f32_16x16x32_bf16 v[96:99], v[60:63], v[48:51], v[96:99]
    ds_read_b64_tr_b16 v[68:69], v30 offset:4096
    s_waitcnt lgkmcnt(3)
    v_mfma_f32_16x16x32_bf16 v[100:103], v[64:67], v[44:47], v[100:103]
    ds_read_b64_tr_b16 v[70:71], v30 offset:4608
    ds_read_b64_tr_b16 v[72:73], v31 offset:4096
    v_mfma_f32_16x16x32_bf16 v[104:107], v[64:67], v[48:51], v[104:107]
    ds_read_b64_tr_b16 v[74:75], v31 offset:4608
    s_waitcnt lgkmcnt(2)
    v_mfma_f32_16x16x32_bf16 v[92:95], v[68:71], v[52:55], v[92:95]
    ds_read_b128 v[44:47], v16 offset:0
    ds_read_b128 v[48:51], v16 offset:2048
    v_mfma_f32_16x16x32_bf16 v[96:99], v[68:71], v[56:59], v[96:99]
    ds_read_b64_tr_b16 v[60:61], v32 offset:0
    s_waitcnt lgkmcnt(3)
    v_mfma_f32_16x16x32_bf16 v[100:103], v[72:75], v[52:55], v[100:103]
    ds_read_b64_tr_b16 v[62:63], v32 offset:512
    ds_read_b64_tr_b16 v[64:65], v33 offset:0
    v_mfma_f32_16x16x32_bf16 v[104:107], v[72:75], v[56:59], v[104:107]
    ds_read_b64_tr_b16 v[66:67], v33 offset:512
    s_barrier
    s_waitcnt lgkmcnt(2)
    v_mfma_f32_16x16x32_bf16 v[92:95], v[60:63], v[44:47], v[92:95]
    ds_read_b128 v[52:55], v17 offset:0
    ds_read_b128 v[56:59], v17 offset:2048
    v_mfma_f32_16x16x32_bf16 v[96:99], v[60:63], v[48:51], v[96:99]
    ds_read_b64_tr_b16 v[68:69], v32 offset:4096
    s_waitcnt lgkmcnt(3)
    v_mfma_f32_16x16x32_bf16 v[100:103], v[64:67], v[44:47], v[100:103]
    ds_read_b64_tr_b16 v[70:71], v32 offset:4608
    ds_read_b64_tr_b16 v[72:73], v33 offset:4096
    v_mfma_f32_16x16x32_bf16 v[104:107], v[64:67], v[48:51], v[104:107]
    ds_read_b64_tr_b16 v[74:75], v33 offset:4608
    s_waitcnt lgkmcnt(2)
    v_mfma_f32_16x16x32_bf16 v[92:95], v[68:71], v[52:55], v[92:95]
    ds_read_b128 v[44:47], v2 offset:0
    ds_read_b128 v[48:51], v2 offset:2048
    v_mfma_f32_16x16x32_bf16 v[96:99], v[68:71], v[56:59], v[96:99]
    ds_read_b64_tr_b16 v[60:61], v18 offset:0
    s_waitcnt lgkmcnt(3)
    v_mfma_f32_16x16x32_bf16 v[100:103], v[72:75], v[52:55], v[100:103]
    ds_read_b64_tr_b16 v[62:63], v18 offset:512
    ds_read_b64_tr_b16 v[64:65], v19 offset:0
    v_mfma_f32_16x16x32_bf16 v[104:107], v[72:75], v[56:59], v[104:107]
    ds_read_b64_tr_b16 v[66:67], v19 offset:512
    s_barrier
    s_waitcnt lgkmcnt(2)
    v_mfma_f32_16x16x32_bf16 v[92:95], v[60:63], v[44:47], v[92:95]
    ds_read_b128 v[52:55], v3 offset:0
    ds_read_b128 v[56:59], v3 offset:2048
    v_mfma_f32_16x16x32_bf16 v[96:99], v[60:63], v[48:51], v[96:99]
    ds_read_b64_tr_b16 v[68:69], v18 offset:4096
    s_waitcnt lgkmcnt(3)
    v_mfma_f32_16x16x32_bf16 v[100:103], v[64:67], v[44:47], v[100:103]
    ds_read_b64_tr_b16 v[70:71], v18 offset:4608
    ds_read_b64_tr_b16 v[72:73], v19 offset:4096
    v_mfma_f32_16x16x32_bf16 v[104:107], v[64:67], v[48:51], v[104:107]
    ds_read_b64_tr_b16 v[74:75], v19 offset:4608
    s_waitcnt lgkmcnt(2)
    v_mfma_f32_16x16x32_bf16 v[92:95], v[68:71], v[52:55], v[92:95]
    ds_read_b128 v[44:47], v4 offset:0
    ds_read_b128 v[48:51], v4 offset:2048
    v_mfma_f32_16x16x32_bf16 v[96:99], v[68:71], v[56:59], v[96:99]
    ds_read_b64_tr_b16 v[60:61], v20 offset:0
    s_waitcnt lgkmcnt(3)
    v_mfma_f32_16x16x32_bf16 v[100:103], v[72:75], v[52:55], v[100:103]
    ds_read_b64_tr_b16 v[62:63], v20 offset:512
    ds_read_b64_tr_b16 v[64:65], v21 offset:0
    v_mfma_f32_16x16x32_bf16 v[104:107], v[72:75], v[56:59], v[104:107]
    ds_read_b64_tr_b16 v[66:67], v21 offset:512
    s_barrier
    s_waitcnt lgkmcnt(2)
    v_mfma_f32_16x16x32_bf16 v[92:95], v[60:63], v[44:47], v[92:95]
    ds_read_b128 v[52:55], v5 offset:0
    ds_read_b128 v[56:59], v5 offset:2048
    v_mfma_f32_16x16x32_bf16 v[96:99], v[60:63], v[48:51], v[96:99]
    ds_read_b64_tr_b16 v[68:69], v20 offset:4096
    s_waitcnt lgkmcnt(3)
    v_mfma_f32_16x16x32_bf16 v[100:103], v[64:67], v[44:47], v[100:103]
    ds_read_b64_tr_b16 v[70:71], v20 offset:4608
    ds_read_b64_tr_b16 v[72:73], v21 offset:4096
    v_mfma_f32_16x16x32_bf16 v[104:107], v[64:67], v[48:51], v[104:107]
    ds_read_b64_tr_b16 v[74:75], v21 offset:4608
    s_waitcnt lgkmcnt(2)
    v_mfma_f32_16x16x32_bf16 v[92:95], v[68:71], v[52:55], v[92:95]
    ds_read_b128 v[44:47], v6 offset:0
    ds_read_b128 v[48:51], v6 offset:2048
    v_mfma_f32_16x16x32_bf16 v[96:99], v[68:71], v[56:59], v[96:99]
    ds_read_b64_tr_b16 v[60:61], v22 offset:0
    s_waitcnt lgkmcnt(3)
    v_mfma_f32_16x16x32_bf16 v[100:103], v[72:75], v[52:55], v[100:103]
    ds_read_b64_tr_b16 v[62:63], v22 offset:512
    ds_read_b64_tr_b16 v[64:65], v23 offset:0
    v_mfma_f32_16x16x32_bf16 v[104:107], v[72:75], v[56:59], v[104:107]
    ds_read_b64_tr_b16 v[66:67], v23 offset:512
    s_waitcnt lgkmcnt(2)
    v_mfma_f32_16x16x32_bf16 v[92:95], v[60:63], v[44:47], v[92:95]
    ds_read_b128 v[52:55], v7 offset:0
    ds_read_b128 v[56:59], v7 offset:2048
    v_mfma_f32_16x16x32_bf16 v[96:99], v[60:63], v[48:51], v[96:99]
    ds_read_b64_tr_b16 v[68:69], v22 offset:4096
    s_waitcnt lgkmcnt(3)
    v_mfma_f32_16x16x32_bf16 v[100:103], v[64:67], v[44:47], v[100:103]
    ds_read_b64_tr_b16 v[70:71], v22 offset:4608
    ds_read_b64_tr_b16 v[72:73], v23 offset:4096
    v_mfma_f32_16x16x32_bf16 v[104:107], v[64:67], v[48:51], v[104:107]
    ds_read_b64_tr_b16 v[74:75], v23 offset:4608
    s_waitcnt lgkmcnt(2)
    v_mfma_f32_16x16x32_bf16 v[92:95], v[68:71], v[52:55], v[92:95]
    v_mfma_f32_16x16x32_bf16 v[96:99], v[68:71], v[56:59], v[96:99]
    s_waitcnt lgkmcnt(0)
    v_mfma_f32_16x16x32_bf16 v[100:103], v[72:75], v[52:55], v[100:103]
    v_mfma_f32_16x16x32_bf16 v[104:107], v[72:75], v[56:59], v[104:107]
    s_waitcnt vmcnt(0)
    v_sub_f32 v76, v76, v92
    v_fmac_f32 v92, v110, v76
    v_sub_f32 v77, v77, v93
    v_fmac_f32 v93, v110, v77
    v_sub_f32 v78, v78, v94
    v_fmac_f32 v94, v110, v78
    v_sub_f32 v79, v79, v95
    v_fmac_f32 v95, v110, v79
    v_cvt_pk_bf16_f32 v36, v92, v93
    v_cvt_pk_bf16_f32 v37, v94, v95
    ds_write_b64 v108, v[36:37] offset:0
    v_sub_f32 v80, v80, v96
    v_fmac_f32 v96, v111, v80
    v_sub_f32 v81, v81, v97
    v_fmac_f32 v97, v111, v81
    v_sub_f32 v82, v82, v98
    v_fmac_f32 v98, v111, v82
    v_sub_f32 v83, v83, v99
    v_fmac_f32 v99, v111, v83
    v_cvt_pk_bf16_f32 v38, v96, v97
    v_cvt_pk_bf16_f32 v39, v98, v99
    ds_write_b64 v108, v[38:39] offset:2304
    v_sub_f32 v84, v84, v100
    v_fmac_f32 v100, v110, v84
    v_sub_f32 v85, v85, v101
    v_fmac_f32 v101, v110, v85
    v_sub_f32 v86, v86, v102
    v_fmac_f32 v102, v110, v86
    v_sub_f32 v87, v87, v103
    v_fmac_f32 v103, v110, v87
    v_cvt_pk_bf16_f32 v40, v100, v101
    v_cvt_pk_bf16_f32 v41, v102, v103
    ds_write_b64 v108, v[40:41] offset:32
    v_sub_f32 v88, v88, v104
    v_fmac_f32 v104, v111, v88
    v_sub_f32 v89, v89, v105
    v_fmac_f32 v105, v111, v89
    v_sub_f32 v90, v90, v106
    v_fmac_f32 v106, v111, v90
    v_sub_f32 v91, v91, v107
    v_fmac_f32 v107, v111, v91
    v_cvt_pk_bf16_f32 v42, v104, v105
    v_cvt_pk_bf16_f32 v43, v106, v107
    ds_write_b64 v108, v[42:43] offset:2336
    s_waitcnt lgkmcnt(0)
    s_barrier
    ds_read_b128 v[76:79], v112 offset:0
    ds_read_b128 v[80:83], v112 offset:1152
    s_waitcnt lgkmcnt(1)
    buffer_store_dwordx4 v[76:79], v113, s[4:7], s71 offen
    s_waitcnt lgkmcnt(0)
    s_add_u32 s71, s71, 8192
    buffer_store_dwordx4 v[80:83], v113, s[4:7], s71 offen
k3_end:
k3_exit:
    s_endpgm
k3_loader:
    s_mov_b32 s4, s28
    s_mov_b32 s5, s29
    s_mov_b32 s6, 0x800000
    s_mov_b32 s7, 0x00020000
    s_add_u32 s8, s40, 16777216
    s_addc_u32 s9, s41, 0
    s_mov_b32 s10, 0x300000
    s_mov_b32 s11, 0x00020000
    s_add_u32 s12, s40, 20971520
    s_addc_u32 s13, s41, 0
    s_mov_b32 s14, 0x200000
    s_mov_b32 s15, 0x00020000
    s_mov_b32 s16, s32
    s_mov_b32 s17, s33
    s_mov_b32 s18, 0x80000
    s_mov_b32 s19, 0x00020000
    s_add_u32 s20, s40, 25165824
    s_addc_u32 s21, s41, 0
    s_mov_b32 s22, 0x2c0000
    s_mov_b32 s23, 0x00020000
    s_mov_b32 s52, s34
    s_mov_b32 s53, s35
    s_mov_b32 s54, 0xac000
    s_mov_b32 s55, 0x00020000
    v_lshrrev_b32 v48, 3, v1
    v_and_b32 v49, 7, v1
    v_xor_b32 v49, v49, v48
    v_lshlrev_b32 v49, 4, v49
    s_mov_b32 s65, 4096
    v_mul_lo_u32 v2, v48, s65
    v_add_u32 v2, v2, v49
    v_add_u32 v48, 0, v1
    s_mov_b32 s65, 5462
    v_mul_lo_u32 v49, v48, s65
    v_lshrrev_b32 v49, 16, v49
    v_mul_u32_u24 v50, 12, v49
    v_sub_u32 v50, v48, v50
    v_bfe_u32 v51, v49, 3, 1
    v_lshlrev_b32 v51, 1, v51
    v_xor_b32 v50, v50, v51
    v_lshlrev_b32 v50, 4, v50
    s_mov_b32 s65, 192
    v_mul_lo_u32 v3, v49, s65
    v_add_u32 v3, v3, v50
    v_add_u32 v48, 64, v1
    s_mov_b32 s65, 5462
    v_mul_lo_u32 v49, v48, s65
    v_lshrrev_b32 v49, 16, v49
    v_mul_u32_u24 v50, 12, v49
    v_sub_u32 v50, v48, v50
    v_bfe_u32 v51, v49, 3, 1
    v_lshlrev_b32 v51, 1, v51
    v_xor_b32 v50, v50, v51
    v_lshlrev_b32 v50, 4, v50
    s_mov_b32 s65, 192
    v_mul_lo_u32 v4, v49, s65
    v_add_u32 v4, v4, v50
    v_add_u32 v48, 128, v1
    s_mov_b32 s65, 5462
    v_mul_lo_u32 v49, v48, s65
    v_lshrrev_b32 v49, 16, v49
    v_mul_u32_u24 v50, 12, v49
    v_sub_u32 v50, v48, v50
    v_bfe_u32 v51, v49, 3, 1
    v_lshlrev_b32 v51, 1, v51
    v_xor_b32 v50, v50, v51
    v_lshlrev_b32 v50, 4, v50
    s_mov_b32 s65, 192
    v_mul_lo_u32 v5, v49, s65
    v_add_u32 v5, v5, v50
    s_lshl_b32 s65, s60, 4
    s_add_u32 s65, s65, s44
    s_lshl_b32 s66, s65, 12
    s_lshl_b32 s65, s60, 4
    s_mul_i32 s65, s65, 192
    s_mul_i32 s57, s46, 393216
    s_add_u32 s68, s65, s57
    s_add_u32 s48, s66, 4096
    s_add_u32 s49, s68, 393216
    s_add_u32 m0, s63, 0
    s_add_u32 s65, s66, 0
    buffer_load_dwordx4 v2, s[4:7], s65 offen lds
    s_add_u32 m0, s63, 1024
    s_add_u32 s65, s66, 32768
    buffer_load_dwordx4 v2, s[4:7], s65 offen lds
    s_add_u32 s66, s66, 128
    s_add_u32 m0, s63, 20480
    s_add_u32 s65, s66, 0
    buffer_load_dwordx4 v2, s[4:7], s65 offen lds
    s_add_u32 m0, s63, 21504
    s_add_u32 s65, s66, 32768
    buffer_load_dwordx4 v2, s[4:7], s65 offen lds
    s_add_u32 s66, s66, 128
    s_add_u32 m0, s63, 40960
    s_add_u32 s65, s66, 0
    buffer_load_dwordx4 v2, s[4:7], s65 offen lds
    s_add_u32 m0, s63, 41984
    s_add_u32 s65, s66, 32768
    buffer_load_dwordx4 v2, s[4:7], s65 offen lds
    s_add_u32 s66, s66, 128
    s_add_u32 m0, s63, 61440
    s_add_u32 s65, s66, 0
    buffer_load_dwordx4 v2, s[4:7], s65 offen lds
    s_add_u32 m0, s63, 62464
    s_add_u32 s65, s66, 32768
    buffer_load_dwordx4 v2, s[4:7], s65 offen lds
    s_add_u32 s66, s66, 128
    s_add_u32 m0, s63, 81920
    s_add_u32 s65, s66, 0
    buffer_load_dwordx4 v2, s[4:7], s65 offen lds
    s_add_u32 m0, s63, 82944
    s_add_u32 s65, s66, 32768
    buffer_load_dwordx4 v2, s[4:7], s65 offen lds
    s_add_u32 s66, s66, 128
    s_add_u32 m0, s63, 102400
    s_add_u32 s65, s66, 0
    buffer_load_dwordx4 v2, s[4:7], s65 offen lds
    s_add_u32 m0, s63, 103424
    s_add_u32 s65, s66, 32768
    buffer_load_dwordx4 v2, s[4:7], s65 offen lds
    s_add_u32 s66, s66, 128
    s_add_u32 m0, s63, 122880
    s_add_u32 s65, s66, 0
    buffer_load_dwordx4 v2, s[4:7], s65 offen lds
    s_add_u32 m0, s63, 123904
    s_add_u32 s65, s66, 32768
    buffer_load_dwordx4 v2, s[4:7], s65 offen lds
    s_add_u32 s66, s66, 128
    s_mul_i32 s90, s60, 2048
    s_mul_i32 s91, s60, 2048
    s_add_u32 s91, s91, 8192
    v_lshrrev_b32 v36, 3, v1
    v_and_b32 v37, 7, v1
    v_xor_b32 v37, v37, v36
    v_lshlrev_b32 v37, 4, v37
    s_mov_b32 s65, 1024
    v_mul_lo_u32 v10, v36, s65
    v_add_u32 v10, v10, v37
    v_add_u32 v36, 0, v1
    s_mov_b32 s65, 8192
    v_mul_lo_u32 v37, v36, s65
    v_lshrrev_b32 v37, 16, v37
    v_mul_u32_u24 v38, 8, v37
    v_sub_u32 v38, v36, v38
    v_bfe_u32 v39, v37, 1, 1
    v_bfe_u32 v40, v37, 3, 1
    v_lshl_or_b32 v39, v40, 1, v39
    v_lshlrev_b32 v39, 1, v39
    v_xor_b32 v38, v38, v39
    v_lshlrev_b32 v38, 4, v38
    s_mov_b32 s65, 1024
    v_mul_lo_u32 v12, v37, s65
    v_add_u32 v12, v12, v38
    v_add_u32 v36, 64, v1
    s_mov_b32 s65, 8192
    v_mul_lo_u32 v37, v36, s65
    v_lshrrev_b32 v37, 16, v37
    v_mul_u32_u24 v38, 8, v37
    v_sub_u32 v38, v36, v38
    v_bfe_u32 v39, v37, 1, 1
    v_bfe_u32 v40, v37, 3, 1
    v_lshl_or_b32 v39, v40, 1, v39
    v_lshlrev_b32 v39, 1, v39
    v_xor_b32 v38, v38, v39
    v_lshlrev_b32 v38, 4, v38
    s_mov_b32 s65, 1024
    v_mul_lo_u32 v13, v37, s65
    v_add_u32 v13, v13, v38
    v_lshrrev_b32 v36, 3, v1
    v_and_b32 v37, 7, v1
    v_xor_b32 v37, v37, v36
    v_lshlrev_b32 v37, 4, v37
    s_mov_b32 s65, 1408
    v_mul_lo_u32 v11, v36, s65
    v_add_u32 v11, v11, v37
    v_add_u32 v36, 0, v1
    s_mov_b32 s65, 8192
    v_mul_lo_u32 v37, v36, s65
    v_lshrrev_b32 v37, 16, v37
    v_mul_u32_u24 v38, 8, v37
    v_sub_u32 v38, v36, v38
    v_bfe_u32 v39, v37, 1, 1
    v_bfe_u32 v40, v37, 3, 1
    v_lshl_or_b32 v39, v40, 1, v39
    v_lshlrev_b32 v39, 1, v39
    v_xor_b32 v38, v38, v39
    v_lshlrev_b32 v38, 4, v38
    s_mov_b32 s65, 1024
    v_mul_lo_u32 v14, v37, s65
    v_add_u32 v14, v14, v38
    v_add_u32 v36, 64, v1
    s_mov_b32 s65, 8192
    v_mul_lo_u32 v37, v36, s65
    v_lshrrev_b32 v37, 16, v37
    v_mul_u32_u24 v38, 8, v37
    v_sub_u32 v38, v36, v38
    v_bfe_u32 v39, v37, 1, 1
    v_bfe_u32 v40, v37, 3, 1
    v_lshl_or_b32 v39, v40, 1, v39
    v_lshlrev_b32 v39, 1, v39
    v_xor_b32 v38, v38, v39
    v_lshlrev_b32 v38, 4, v38
    s_mov_b32 s65, 1024
    v_mul_lo_u32 v15, v37, s65
    v_add_u32 v15, v15, v38
    s_lshl_b32 s65, s60, 4
    s_add_u32 s65, s65, s44
    s_lshl_b32 s86, s65, 10
    s_mul_i32 s87, s65, 1408
    s_lshl_b32 s65, s60, 14
    s_lshl_b32 s57, s46, 7
    s_add_u32 s88, s65, s57
    s_mov_b32 s89, s88
    v_mov_b32 v21, 0
    v_lshlrev_b32 v22, 2, v1
k3_plz2:
    buffer_load_dword v23, v22, s[24:27], s92 offen sc1
    s_waitcnt vmcnt(0)
    v_cmp_ne_u32 vcc, v23, v236
    s_nop 3
    s_and_b32 s70, vcc_lo, 0xffff
    s_cmp_eq_u32 s70, 0
    s_cbranch_scc1 k3_pdz2
    s_sleep 4
    s_branch k3_plz2
k3_pdz2:
    s_add_u32 m0, s64, 0
    s_nop 0
    buffer_load_dwordx4 v3, s[8:11], s68 offen lds
    s_add_u32 m0, s64, 1024
    s_nop 0
    buffer_load_dwordx4 v4, s[8:11], s68 offen lds
    s_add_u32 m0, s64, 2048
    s_nop 0
    buffer_load_dwordx4 v5, s[8:11], s68 offen lds
    s_add_u32 s68, s68, 12288
    s_add_u32 m0, s64, 20480
    s_nop 0
    buffer_load_dwordx4 v3, s[8:11], s68 offen lds
    s_add_u32 m0, s64, 21504
    s_nop 0
    buffer_load_dwordx4 v4, s[8:11], s68 offen lds
    s_add_u32 m0, s64, 22528
    s_nop 0
    buffer_load_dwordx4 v5, s[8:11], s68 offen lds
    s_add_u32 s68, s68, 12288
    s_add_u32 m0, s64, 40960
    s_nop 0
    buffer_load_dwordx4 v3, s[8:11], s68 offen lds
    s_add_u32 m0, s64, 41984
    s_nop 0
    buffer_load_dwordx4 v4, s[8:11], s68 offen lds
    s_add_u32 m0, s64, 43008
    s_nop 0
    buffer_load_dwordx4 v5, s[8:11], s68 offen lds
    s_add_u32 s68, s68, 12288
    s_add_u32 m0, s64, 61440
    s_nop 0
    buffer_load_dwordx4 v3, s[8:11], s68 offen lds
    s_add_u32 m0, s64, 62464
    s_nop 0
    buffer_load_dwordx4 v4, s[8:11], s68 offen lds
    s_add_u32 m0, s64, 63488
    s_nop 0
    buffer_load_dwordx4 v5, s[8:11], s68 offen lds
    s_add_u32 s68, s68, 12288
    s_add_u32 m0, s64, 81920
    s_nop 0
    buffer_load_dwordx4 v3, s[8:11], s68 offen lds
    s_add_u32 m0, s64, 82944
    s_nop 0
    buffer_load_dwordx4 v4, s[8:11], s68 offen lds
    s_add_u32 m0, s64, 83968
    s_nop 0
    buffer_load_dwordx4 v5, s[8:11], s68 offen lds
    s_add_u32 s68, s68, 12288
    s_add_u32 m0, s64, 102400
    s_nop 0
    buffer_load_dwordx4 v3, s[8:11], s68 offen lds
    s_add_u32 m0, s64, 103424
    s_nop 0
    buffer_load_dwordx4 v4, s[8:11], s68 offen lds
    s_add_u32 m0, s64, 104448
    s_nop 0
    buffer_load_dwordx4 v5, s[8:11], s68 offen lds
    s_add_u32 s68, s68, 12288
    s_add_u32 m0, s64, 122880
    s_nop 0
    buffer_load_dwordx4 v3, s[8:11], s68 offen lds
    s_add_u32 m0, s64, 123904
    s_nop 0
    buffer_load_dwordx4 v4, s[8:11], s68 offen lds
    s_add_u32 m0, s64, 124928
    s_nop 0
    buffer_load_dwordx4 v5, s[8:11], s68 offen lds
    s_add_u32 s68, s68, 12288
    s_waitcnt vmcnt(18)
    s_barrier
    s_waitcnt vmcnt(15)
    s_barrier
    s_add_u32 m0, s63, 143360
    s_add_u32 s65, s66, 0
    buffer_load_dwordx4 v2, s[4:7], s65 offen lds
    s_add_u32 m0, s63, 144384
    s_add_u32 s65, s66, 32768
    buffer_load_dwordx4 v2, s[4:7], s65 offen lds
    s_add_u32 s66, s66, 128
    s_add_u32 m0, s64, 143360
    s_nop 0
    buffer_load_dwordx4 v3, s[8:11], s68 offen lds
    s_add_u32 m0, s64, 144384
    s_nop 0
    buffer_load_dwordx4 v4, s[8:11], s68 offen lds
    s_add_u32 m0, s64, 145408
    s_nop 0
    buffer_load_dwordx4 v5, s[8:11], s68 offen lds
    s_add_u32 s68, s68, 12288
    s_waitcnt vmcnt(17)
    s_barrier
    s_add_u32 m0, s63, 0
    s_add_u32 s65, s66, 0
    buffer_load_dwordx4 v2, s[4:7], s65 offen lds
    s_add_u32 m0, s63, 1024
    s_add_u32 s65, s66, 32768
    buffer_load_dwordx4 v2, s[4:7], s65 offen lds
    s_add_u32 s66, s66, 128
    s_add_u32 m0, s64, 0
    s_nop 0
    buffer_load_dwordx4 v3, s[8:11], s68 offen lds
    s_add_u32 m0, s64, 1024
    s_nop 0
    buffer_load_dwordx4 v4, s[8:11], s68 offen lds
    s_add_u32 m0, s64, 2048
    s_nop 0
    buffer_load_dwordx4 v5, s[8:11], s68 offen lds
    s_add_u32 s68, s68, 12288
    s_waitcnt vmcnt(19)
    s_barrier
    s_add_u32 m0, s63, 20480
    s_add_u32 s65, s66, 0
    buffer_load_dwordx4 v2, s[4:7], s65 offen lds
    s_add_u32 m0, s63, 21504
    s_add_u32 s65, s66, 32768
    buffer_load_dwordx4 v2, s[4:7], s65 offen lds
    s_add_u32 s66, s66, 128
    s_add_u32 m0, s64, 20480
    s_nop 0
    buffer_load_dwordx4 v3, s[8:11], s68 offen lds
    s_add_u32 m0, s64, 21504
    s_nop 0
    buffer_load_dwordx4 v4, s[8:11], s68 offen lds
    s_add_u32 m0, s64, 22528
    s_nop 0
    buffer_load_dwordx4 v5, s[8:11], s68 offen lds
    s_add_u32 s68, s68, 12288
    s_waitcnt vmcnt(21)
    s_barrier
    s_add_u32 m0, s63, 40960
    s_add_u32 s65, s66, 0
    buffer_load_dwordx4 v2, s[4:7], s65 offen lds
    s_add_u32 m0, s63, 41984
    s_add_u32 s65, s66, 32768
    buffer_load_dwordx4 v2, s[4:7], s65 offen lds
    s_add_u32 s66, s66, 128
    s_add_u32 m0, s64, 40960
    s_nop 0
    buffer_load_dwordx4 v3, s[8:11], s68 offen lds
    s_add_u32 m0, s64, 41984
    s_nop 0
    buffer_load_dwordx4 v4, s[8:11], s68 offen lds
    s_add_u32 m0, s64, 43008
    s_nop 0
    buffer_load_dwordx4 v5, s[8:11], s68 offen lds
    s_add_u32 s68, s68, 12288
    s_waitcnt vmcnt(23)
    s_barrier
    s_add_u32 m0, s63, 61440
    s_add_u32 s65, s66, 0
    buffer_load_dwordx4 v2, s[4:7], s65 offen lds
    s_add_u32 m0, s63, 62464
    s_add_u32 s65, s66, 32768
    buffer_load_dwordx4 v2, s[4:7], s65 offen lds
    s_add_u32 s66, s66, 128
    s_add_u32 m0, s64, 61440
    s_nop 0
    buffer_load_dwordx4 v3, s[8:11], s68 offen lds
    s_add_u32 m0, s64, 62464
    s_nop 0
    buffer_load_dwordx4 v4, s[8:11], s68 offen lds
    s_add_u32 m0, s64, 63488
    s_nop 0
    buffer_load_dwordx4 v5, s[8:11], s68 offen lds
    s_add_u32 s68, s68, 12288
    s_waitcnt vmcnt(25)
    s_barrier
    s_add_u32 m0, s63, 81920
    s_add_u32 s65, s66, 0
    buffer_load_dwordx4 v2, s[4:7], s65 offen lds
    s_add_u32 m0, s63, 82944
    s_add_u32 s65, s66, 32768
    buffer_load_dwordx4 v2, s[4:7], s65 offen lds
    s_add_u32 s66, s66, 128
    s_add_u32 m0, s64, 81920
    s_nop 0
    buffer_load_dwordx4 v3, s[8:11], s68 offen lds
    s_add_u32 m0, s64, 82944
    s_nop 0
    buffer_load_dwordx4 v4, s[8:11], s68 offen lds
    s_add_u32 m0, s64, 83968
    s_nop 0
    buffer_load_dwordx4 v5, s[8:11], s68 offen lds
    s_add_u32 s68, s68, 12288
    s_waitcnt vmcnt(25)
    s_barrier
    s_add_u32 m0, s63, 102400
    s_add_u32 s65, s66, 0
    buffer_load_dwordx4 v2, s[4:7], s65 offen lds
    s_add_u32 m0, s63, 103424
    s_add_u32 s65, s66, 32768
    buffer_load_dwordx4 v2, s[4:7], s65 offen lds
    s_add_u32 s66, s66, 128
    s_add_u32 m0, s64, 102400
    s_nop 0
    buffer_load_dwordx4 v3, s[8:11], s68 offen lds
    s_add_u32 m0, s64, 103424
    s_nop 0
    buffer_load_dwordx4 v4, s[8:11], s68 offen lds
    s_add_u32 m0, s64, 104448
    s_nop 0
    buffer_load_dwordx4 v5, s[8:11], s68 offen lds
    s_add_u32 s68, s68, 12288
    s_waitcnt vmcnt(25)
    s_barrier
    s_add_u32 m0, s63, 122880
    s_add_u32 s65, s66, 0
    buffer_load_dwordx4 v2, s[4:7], s65 offen lds
    s_add_u32 m0, s63, 123904
    s_add_u32 s65, s66, 32768
    buffer_load_dwordx4 v2, s[4:7], s65 offen lds
    s_add_u32 s66, s66, 128
    s_add_u32 m0, s64, 122880
    s_nop 0
    buffer_load_dwordx4 v3, s[8:11], s68 offen lds
    s_add_u32 m0, s64, 123904
    s_nop 0
    buffer_load_dwordx4 v4, s[8:11], s68 offen lds
    s_add_u32 m0, s64, 124928
    s_nop 0
    buffer_load_dwordx4 v5, s[8:11], s68 offen lds
    s_add_u32 s68, s68, 12288
    s_mov_b32 s70, 0
k3_lloop:
    s_waitcnt vmcnt(25)
    s_barrier
    s_add_u32 m0, s63, 143360
    s_add_u32 s65, s66, 0
    buffer_load_dwordx4 v2, s[4:7], s65 offen lds
    s_add_u32 m0, s63, 144384
    s_add_u32 s65, s66, 32768
    buffer_load_dwordx4 v2, s[4:7], s65 offen lds
    s_add_u32 s66, s66, 128
    s_add_u32 m0, s64, 143360
    s_nop 0
    buffer_load_dwordx4 v3, s[8:11], s68 offen lds
    s_add_u32 m0, s64, 144384
    s_nop 0
    buffer_load_dwordx4 v4, s[8:11], s68 offen lds
    s_add_u32 m0, s64, 145408
    s_nop 0
    buffer_load_dwordx4 v5, s[8:11], s68 offen lds
    s_add_u32 s68, s68, 12288
    s_waitcnt vmcnt(25)
    s_barrier
    s_add_u32 m0, s63, 0
    s_add_u32 s65, s66, 0
    buffer_load_dwordx4 v2, s[4:7], s65 offen lds
    s_add_u32 m0, s63, 1024
    s_add_u32 s65, s66, 32768
    buffer_load_dwordx4 v2, s[4:7], s65 offen lds
    s_add_u32 s66, s66, 128
    s_add_u32 m0, s64, 0
    s_nop 0
    buffer_load_dwordx4 v3, s[8:11], s68 offen lds
    s_add_u32 m0, s64, 1024
    s_nop 0
    buffer_load_dwordx4 v4, s[8:11], s68 offen lds
    s_add_u32 m0, s64, 2048
    s_nop 0
    buffer_load_dwordx4 v5, s[8:11], s68 offen lds
    s_add_u32 s68, s68, 12288
    s_waitcnt vmcnt(25)
    s_barrier
    s_add_u32 m0, s63, 20480
    s_add_u32 s65, s66, 0
    buffer_load_dwordx4 v2, s[4:7], s65 offen lds
    s_add_u32 m0, s63, 21504
    s_add_u32 s65, s66, 32768
    buffer_load_dwordx4 v2, s[4:7], s65 offen lds
    s_add_u32 s66, s66, 128
    s_add_u32 m0, s64, 20480
    s_nop 0
    buffer_load_dwordx4 v3, s[8:11], s68 offen lds
    s_add_u32 m0, s64, 21504
    s_nop 0
    buffer_load_dwordx4 v4, s[8:11], s68 offen lds
    s_add_u32 m0, s64, 22528
    s_nop 0
    buffer_load_dwordx4 v5, s[8:11], s68 offen lds
    s_add_u32 s68, s68, 12288
    s_waitcnt vmcnt(25)
    s_barrier
    s_add_u32 m0, s63, 40960
    s_add_u32 s65, s66, 0
    buffer_load_dwordx4 v2, s[4:7], s65 offen lds
    s_add_u32 m0, s63, 41984
    s_add_u32 s65, s66, 32768
    buffer_load_dwordx4 v2, s[4:7], s65 offen lds
    s_add_u32 s66, s66, 128
    s_add_u32 m0, s64, 40960
    s_nop 0
    buffer_load_dwordx4 v3, s[8:11], s68 offen lds
    s_add_u32 m0, s64, 41984
    s_nop 0
    buffer_load_dwordx4 v4, s[8:11], s68 offen lds
    s_add_u32 m0, s64, 43008
    s_nop 0
    buffer_load_dwordx4 v5, s[8:11], s68 offen lds
    s_add_u32 s68, s68, 12288
    s_waitcnt vmcnt(25)
    s_barrier
    s_add_u32 m0, s63, 61440
    s_add_u32 s65, s66, 0
    buffer_load_dwordx4 v2, s[4:7], s65 offen lds
    s_add_u32 m0, s63, 62464
    s_add_u32 s65, s66, 32768
    buffer_load_dwordx4 v2, s[4:7], s65 offen lds
    s_add_u32 s66, s66, 128
    s_add_u32 m0, s64, 61440
    s_nop 0
    buffer_load_dwordx4 v3, s[8:11], s68 offen lds
    s_add_u32 m0, s64, 62464
    s_nop 0
    buffer_load_dwordx4 v4, s[8:11], s68 offen lds
    s_add_u32 m0, s64, 63488
    s_nop 0
    buffer_load_dwordx4 v5, s[8:11], s68 offen lds
    s_add_u32 s68, s68, 12288
    s_waitcnt vmcnt(25)
    s_barrier
    s_add_u32 m0, s63, 81920
    s_add_u32 s65, s66, 0
    buffer_load_dwordx4 v2, s[4:7], s65 offen lds
    s_add_u32 m0, s63, 82944
    s_add_u32 s65, s66, 32768
    buffer_load_dwordx4 v2, s[4:7], s65 offen lds
    s_add_u32 s66, s66, 128
    s_add_u32 m0, s64, 81920
    s_nop 0
    buffer_load_dwordx4 v3, s[8:11], s68 offen lds
    s_add_u32 m0, s64, 82944
    s_nop 0
    buffer_load_dwordx4 v4, s[8:11], s68 offen lds
    s_add_u32 m0, s64, 83968
    s_nop 0
    buffer_load_dwordx4 v5, s[8:11], s68 offen lds
    s_add_u32 s68, s68, 12288
    s_waitcnt vmcnt(25)
    s_barrier
    s_add_u32 m0, s63, 102400
    s_add_u32 s65, s66, 0
    buffer_load_dwordx4 v2, s[4:7], s65 offen lds
    s_add_u32 m0, s63, 103424
    s_add_u32 s65, s66, 32768
    buffer_load_dwordx4 v2, s[4:7], s65 offen lds
    s_add_u32 s66, s66, 128
    s_add_u32 m0, s64, 102400
    s_nop 0
    buffer_load_dwordx4 v3, s[8:11], s68 offen lds
    s_add_u32 m0, s64, 103424
    s_nop 0
    buffer_load_dwordx4 v4, s[8:11], s68 offen lds
    s_add_u32 m0, s64, 104448
    s_nop 0
    buffer_load_dwordx4 v5, s[8:11], s68 offen lds
    s_add_u32 s68, s68, 12288
    s_waitcnt vmcnt(25)
    s_barrier
    s_add_u32 m0, s63, 122880
    s_add_u32 s65, s66, 0
    buffer_load_dwordx4 v2, s[4:7], s65 offen lds
    s_add_u32 m0, s63, 123904
    s_add_u32 s65, s66, 32768
    buffer_load_dwordx4 v2, s[4:7], s65 offen lds
    s_add_u32 s66, s66, 128
    s_add_u32 m0, s64, 122880
    s_nop 0
    buffer_load_dwordx4 v3, s[8:11], s68 offen lds
    s_add_u32 m0, s64, 123904
    s_nop 0
    buffer_load_dwordx4 v4, s[8:11], s68 offen lds
    s_add_u32 m0, s64, 124928
    s_nop 0
    buffer_load_dwordx4 v5, s[8:11], s68 offen lds
    s_add_u32 s68, s68, 12288
    s_add_u32 s70, s70, 1
    s_cmp_lt_u32 s70, 2
    s_cbranch_scc1 k3_lloop
    s_waitcnt vmcnt(25)
    s_barrier
    s_add_u32 m0, s63, 143360
    s_add_u32 s65, s66, 0
    buffer_load_dwordx4 v2, s[4:7], s65 offen lds
    s_add_u32 m0, s63, 144384
    s_add_u32 s65, s66, 32768
    buffer_load_dwordx4 v2, s[4:7], s65 offen lds
    s_add_u32 s66, s66, 128
    s_add_u32 m0, s64, 143360
    s_nop 0
    buffer_load_dwordx4 v3, s[8:11], s68 offen lds
    s_add_u32 m0, s64, 144384
    s_nop 0
    buffer_load_dwordx4 v4, s[8:11], s68 offen lds
    s_add_u32 m0, s64, 145408
    s_nop 0
    buffer_load_dwordx4 v5, s[8:11], s68 offen lds
    s_add_u32 s68, s68, 12288
    s_waitcnt vmcnt(25)
    s_barrier
    v_lshlrev_b32 v22, 2, v1
k3_plql:
    buffer_load_dword v23, v22, s[24:27], s94 offen sc1
    s_waitcnt vmcnt(0)
    v_cmp_ne_u32 vcc, v23, v236
    s_nop 3
    s_and_b32 s70, vcc_lo, 0xff
    s_cmp_eq_u32 s70, 0
    s_cbranch_scc1 k3_pdql
    s_sleep 4
    s_branch k3_plql
k3_pdql:
    s_add_u32 m0, s90, 0
    s_add_u32 s65, s86, 0
    buffer_load_dwordx4 v10, s[12:15], s65 offen lds
    s_add_u32 m0, s90, 1024
    s_add_u32 s65, s86, 8192
    buffer_load_dwordx4 v10, s[12:15], s65 offen lds
    s_add_u32 s86, s86, 128
    s_add_u32 m0, s91, 0
    s_nop 0
    buffer_load_dwordx4 v12, s[16:19], s88 offen lds
    s_add_u32 m0, s91, 1024
    s_nop 0
    buffer_load_dwordx4 v13, s[16:19], s88 offen lds
    s_add_u32 s88, s88, 65536
    s_waitcnt vmcnt(24)
    s_barrier
    s_add_u32 m0, s90, 20480
    s_add_u32 s65, s86, 0
    buffer_load_dwordx4 v10, s[12:15], s65 offen lds
    s_add_u32 m0, s90, 21504
    s_add_u32 s65, s86, 8192
    buffer_load_dwordx4 v10, s[12:15], s65 offen lds
    s_add_u32 s86, s86, 128
    s_add_u32 m0, s91, 20480
    s_nop 0
    buffer_load_dwordx4 v12, s[16:19], s88 offen lds
    s_add_u32 m0, s91, 21504
    s_nop 0
    buffer_load_dwordx4 v13, s[16:19], s88 offen lds
    s_add_u32 s88, s88, 65536
    s_waitcnt vmcnt(23)
    s_barrier
    s_add_u32 m0, s90, 40960
    s_add_u32 s65, s86, 0
    buffer_load_dwordx4 v10, s[12:15], s65 offen lds
    s_add_u32 m0, s90, 41984
    s_add_u32 s65, s86, 8192
    buffer_load_dwordx4 v10, s[12:15], s65 offen lds
    s_add_u32 s86, s86, 128
    s_add_u32 m0, s91, 40960
    s_nop 0
    buffer_load_dwordx4 v12, s[16:19], s88 offen lds
    s_add_u32 m0, s91, 41984
    s_nop 0
    buffer_load_dwordx4 v13, s[16:19], s88 offen lds
    s_add_u32 s88, s88, 65536
    s_waitcnt vmcnt(22)
    s_barrier
    s_add_u32 m0, s90, 61440
    s_add_u32 s65, s86, 0
    buffer_load_dwordx4 v10, s[12:15], s65 offen lds
    s_add_u32 m0, s90, 62464
    s_add_u32 s65, s86, 8192
    buffer_load_dwordx4 v10, s[12:15], s65 offen lds
    s_add_u32 s86, s86, 128
    s_add_u32 m0, s91, 61440
    s_nop 0
    buffer_load_dwordx4 v12, s[16:19], s88 offen lds
    s_add_u32 m0, s91, 62464
    s_nop 0
    buffer_load_dwordx4 v13, s[16:19], s88 offen lds
    s_add_u32 s88, s88, 65536
    s_waitcnt vmcnt(21)
    s_barrier
    s_add_u32 m0, s90, 81920
    s_add_u32 s65, s86, 0
    buffer_load_dwordx4 v10, s[12:15], s65 offen lds
    s_add_u32 m0, s90, 82944
    s_add_u32 s65, s86, 8192
    buffer_load_dwordx4 v10, s[12:15], s65 offen lds
    s_add_u32 s86, s86, 128
    s_add_u32 m0, s91, 81920
    s_nop 0
    buffer_load_dwordx4 v12, s[16:19], s88 offen lds
    s_add_u32 m0, s91, 82944
    s_nop 0
    buffer_load_dwordx4 v13, s[16:19], s88 offen lds
    s_add_u32 s88, s88, 65536
    s_waitcnt vmcnt(20)
    s_barrier
    s_barrier
    s_waitcnt vmcnt(16)
    s_barrier
    s_add_u32 m0, s90, 102400
    s_add_u32 s65, s86, 0
    buffer_load_dwordx4 v10, s[12:15], s65 offen lds
    s_add_u32 m0, s90, 103424
    s_add_u32 s65, s86, 8192
    buffer_load_dwordx4 v10, s[12:15], s65 offen lds
    s_add_u32 s86, s86, 128
    s_add_u32 m0, s91, 102400
    s_nop 0
    buffer_load_dwordx4 v12, s[16:19], s88 offen lds
    s_add_u32 m0, s91, 103424
    s_nop 0
    buffer_load_dwordx4 v13, s[16:19], s88 offen lds
    s_add_u32 s88, s88, 65536
    s_add_u32 m0, s90, 122880
    s_add_u32 s65, s86, 0
    buffer_load_dwordx4 v10, s[12:15], s65 offen lds
    s_add_u32 m0, s90, 123904
    s_add_u32 s65, s86, 8192
    buffer_load_dwordx4 v10, s[12:15], s65 offen lds
    s_add_u32 s86, s86, 128
    s_add_u32 m0, s91, 122880
    s_nop 0
    buffer_load_dwordx4 v12, s[16:19], s88 offen lds
    s_add_u32 m0, s91, 123904
    s_nop 0
    buffer_load_dwordx4 v13, s[16:19], s88 offen lds
    s_add_u32 s88, s88, 65536
    s_waitcnt vmcnt(20)
    s_barrier
    s_add_u32 m0, s90, 143360
    s_add_u32 s65, s86, 0
    buffer_load_dwordx4 v10, s[12:15], s65 offen lds
    s_add_u32 m0, s90, 144384
    s_add_u32 s65, s86, 8192
    buffer_load_dwordx4 v10, s[12:15], s65 offen lds
    s_add_u32 s86, s86, 128
    s_add_u32 m0, s91, 143360
    s_nop 0
    buffer_load_dwordx4 v12, s[16:19], s88 offen lds
    s_add_u32 m0, s91, 144384
    s_nop 0
    buffer_load_dwordx4 v13, s[16:19], s88 offen lds
    s_add_u32 s88, s88, 65536
    s_waitcnt vmcnt(20)
    s_cmp_lg_u32 s60, 0
    s_cbranch_scc1 k3_go
    v_lshlrev_b32 v22, 2, v1
k3_plh:
    buffer_load_dword v23, v22, s[24:27], s95 offen sc1
    s_waitcnt vmcnt(0)
    v_cmp_ne_u32 vcc, v23, v236
    s_nop 3
    s_and_b32 s70, vcc_lo, 0xffffffff
    s_cmp_eq_u32 s70, 0
    s_cbranch_scc1 k3_pdh
    s_sleep 4
    s_branch k3_plh
k3_pdh:
k3_go:
    s_barrier
    s_add_u32 m0, s90, 0
    s_add_u32 s65, s87, 0
    buffer_load_dwordx4 v11, s[20:23], s65 offen lds
    s_add_u32 m0, s90, 1024
    s_add_u32 s65, s87, 11264
    buffer_load_dwordx4 v11, s[20:23], s65 offen lds
    s_add_u32 s87, s87, 128
    s_add_u32 m0, s91, 0
    s_nop 0
    buffer_load_dwordx4 v14, s[52:55], s89 offen lds
    s_add_u32 m0, s91, 1024
    s_nop 0
    buffer_load_dwordx4 v15, s[52:55], s89 offen lds
    s_add_u32 s89, s89, 65536
    s_waitcnt vmcnt(20)
    s_barrier
    s_add_u32 m0, s90, 20480
    s_add_u32 s65, s87, 0
    buffer_load_dwordx4 v11, s[20:23], s65 offen lds
    s_add_u32 m0, s90, 21504
    s_add_u32 s65, s87, 11264
    buffer_load_dwordx4 v11, s[20:23], s65 offen lds
    s_add_u32 s87, s87, 128
    s_add_u32 m0, s91, 20480
    s_nop 0
    buffer_load_dwordx4 v14, s[52:55], s89 offen lds
    s_add_u32 m0, s91, 21504
    s_nop 0
    buffer_load_dwordx4 v15, s[52:55], s89 offen lds
    s_add_u32 s89, s89, 65536
    s_waitcnt vmcnt(20)
    s_barrier
    s_add_u32 m0, s90, 40960
    s_add_u32 s65, s87, 0
    buffer_load_dwordx4 v11, s[20:23], s65 offen lds
    s_add_u32 m0, s90, 41984
    s_add_u32 s65, s87, 11264
    buffer_load_dwordx4 v11, s[20:23], s65 offen lds
    s_add_u32 s87, s87, 128
    s_add_u32 m0, s91, 40960
    s_nop 0
    buffer_load_dwordx4 v14, s[52:55], s89 offen lds
    s_add_u32 m0, s91, 41984
    s_nop 0
    buffer_load_dwordx4 v15, s[52:55], s89 offen lds
    s_add_u32 s89, s89, 65536
    s_waitcnt vmcnt(20)
    s_barrier
    s_add_u32 m0, s90, 61440
    s_add_u32 s65, s87, 0
    buffer_load_dwordx4 v11, s[20:23], s65 offen lds
    s_add_u32 m0, s90, 62464
    s_add_u32 s65, s87, 11264
    buffer_load_dwordx4 v11, s[20:23], s65 offen lds
    s_add_u32 s87, s87, 128
    s_add_u32 m0, s91, 61440
    s_nop 0
    buffer_load_dwordx4 v14, s[52:55], s89 offen lds
    s_add_u32 m0, s91, 62464
    s_nop 0
    buffer_load_dwordx4 v15, s[52:55], s89 offen lds
    s_add_u32 s89, s89, 65536
    s_waitcnt vmcnt(20)
    s_barrier
    s_add_u32 m0, s90, 81920
    s_add_u32 s65, s87, 0
    buffer_load_dwordx4 v11, s[20:23], s65 offen lds
    s_add_u32 m0, s90, 82944
    s_add_u32 s65, s87, 11264
    buffer_load_dwordx4 v11, s[20:23], s65 offen lds
    s_add_u32 s87, s87, 128
    s_add_u32 m0, s91, 81920
    s_nop 0
    buffer_load_dwordx4 v14, s[52:55], s89 offen lds
    s_add_u32 m0, s91, 82944
    s_nop 0
    buffer_load_dwordx4 v15, s[52:55], s89 offen lds
    s_add_u32 s89, s89, 65536
    s_waitcnt vmcnt(20)
    s_barrier
    s_add_u32 m0, s90, 102400
    s_add_u32 s65, s87, 0
    buffer_load_dwordx4 v11, s[20:23], s65 offen lds
    s_add_u32 m0, s90, 103424
    s_add_u32 s65, s87, 11264
    buffer_load_dwordx4 v11, s[20:23], s65 offen lds
    s_add_u32 s87, s87, 128
    s_add_u32 m0, s91, 102400
    s_nop 0
    buffer_load_dwordx4 v14, s[52:55], s89 offen lds
    s_add_u32 m0, s91, 103424
    s_nop 0
    buffer_load_dwordx4 v15, s[52:55], s89 offen lds
    s_add_u32 s89, s89, 65536
    s_waitcnt vmcnt(20)
    s_barrier
    s_add_u32 m0, s90, 122880
    s_add_u32 s65, s87, 0
    buffer_load_dwordx4 v11, s[20:23], s65 offen lds
    s_add_u32 m0, s90, 123904
    s_add_u32 s65, s87, 11264
    buffer_load_dwordx4 v11, s[20:23], s65 offen lds
    s_add_u32 s87, s87, 128
    s_add_u32 m0, s91, 122880
    s_nop 0
    buffer_load_dwordx4 v14, s[52:55], s89 offen lds
    s_add_u32 m0, s91, 123904
    s_nop 0
    buffer_load_dwordx4 v15, s[52:55], s89 offen lds
    s_add_u32 s89, s89, 65536
    s_waitcnt vmcnt(20)
    s_barrier
    s_add_u32 m0, s90, 143360
    s_add_u32 s65, s87, 0
    buffer_load_dwordx4 v11, s[20:23], s65 offen lds
    s_add_u32 m0, s90, 144384
    s_add_u32 s65, s87, 11264
    buffer_load_dwordx4 v11, s[20:23], s65 offen lds
    s_add_u32 s87, s87, 128
    s_add_u32 m0, s91, 143360
    s_nop 0
    buffer_load_dwordx4 v14, s[52:55], s89 offen lds
    s_add_u32 m0, s91, 144384
    s_nop 0
    buffer_load_dwordx4 v15, s[52:55], s89 offen lds
    s_add_u32 s89, s89, 65536
    s_waitcnt vmcnt(20)
    s_barrier
    s_add_u32 m0, s90, 0
    s_add_u32 s65, s87, 0
    buffer_load_dwordx4 v11, s[20:23], s65 offen lds
    s_add_u32 m0, s90, 1024
    s_add_u32 s65, s87, 11264
    buffer_load_dwordx4 v11, s[20:23], s65 offen lds
    s_add_u32 s87, s87, 128
    s_add_u32 m0, s91, 0
    s_nop 0
    buffer_load_dwordx4 v14, s[52:55], s89 offen lds
    s_add_u32 m0, s91, 1024
    s_nop 0
    buffer_load_dwordx4 v15, s[52:55], s89 offen lds
    s_add_u32 s89, s89, 65536
    s_waitcnt vmcnt(20)
    s_barrier
    s_add_u32 m0, s90, 20480
    s_add_u32 s65, s87, 0
    buffer_load_dwordx4 v11, s[20:23], s65 offen lds
    s_add_u32 m0, s90, 21504
    s_add_u32 s65, s87, 11264
    buffer_load_dwordx4 v11, s[20:23], s65 offen lds
    s_add_u32 s87, s87, 128
    s_add_u32 m0, s91, 20480
    s_nop 0
    buffer_load_dwordx4 v14, s[52:55], s89 offen lds
    s_add_u32 m0, s91, 21504
    s_nop 0
    buffer_load_dwordx4 v15, s[52:55], s89 offen lds
    s_add_u32 s89, s89, 65536
    s_waitcnt vmcnt(20)
    s_barrier
    s_add_u32 m0, s90, 40960
    s_add_u32 s65, s87, 0
    buffer_load_dwordx4 v11, s[20:23], s65 offen lds
    s_add_u32 m0, s90, 41984
    s_add_u32 s65, s87, 11264
    buffer_load_dwordx4 v11, s[20:23], s65 offen lds
    s_add_u32 s87, s87, 128
    s_add_u32 m0, s91, 40960
    s_nop 0
    buffer_load_dwordx4 v14, s[52:55], s89 offen lds
    s_add_u32 m0, s91, 41984
    s_nop 0
    buffer_load_dwordx4 v15, s[52:55], s89 offen lds
    s_add_u32 s89, s89, 65536
    s_waitcnt vmcnt(20)
    s_barrier
    s_waitcnt vmcnt(16)
    s_barrier
    s_waitcnt vmcnt(12)
    s_barrier
    s_waitcnt vmcnt(8)
    s_barrier
    s_waitcnt vmcnt(4)
    s_barrier
    s_waitcnt vmcnt(0)
    s_barrier
    s_endpgm
k1_exit:
    s_endpgm
.section .rodata,"a"
.p2align 6
.amdhsa_kernel gated_mix__sliding_local_dilated__mixer_gmlp__prompt_kernel
  .amdhsa_next_free_vgpr 240
  .amdhsa_next_free_sgpr 100
  .amdhsa_accum_offset 240
  .amdhsa_group_segment_fixed_size 0
  .amdhsa_kernarg_size 96
  .amdhsa_user_sgpr_count 2
  .amdhsa_user_sgpr_kernarg_segment_ptr 1
  .amdhsa_system_sgpr_workgroup_id_x 1
.end_amdhsa_kernel
```
